```python
import torch

def _softmax(x, axis=-1):
    return torch.softmax(x, dim=axis)
def _gelu(x):
    return torch.nn.functional.gelu(x, approximate="tanh")
def _silu(x):
    return torch.nn.functional.silu(x)
def _sigmoid(x):
    return torch.sigmoid(x)
def _layernorm(x, axis=-1, eps=1e-5):
    m = x.mean(dim=axis, keepdim=True)
    v = x.var(dim=axis, keepdim=True, unbiased=False)
    return (x - m) / torch.sqrt(v + eps)
def _scatter_add(tgt, idx, src, axis=0):
    return tgt.clone().index_add_(axis, idx, src)
def _segment_sum(src, seg, n):
    out = torch.zeros((n,) + src.shape[1:], dtype=src.dtype)
    return out.index_add_(0, seg, src)
def _pad(x, pw):
    flat = tuple(v for pair in reversed(pw) for v in pair)
    return torch.nn.functional.pad(x, flat)

kernel_name = 'parallel_sum__mha_block_cached__glu_gated_glu__decode'

def setup_inputs():

    _w = (lambda a: (lambda t: t.to(torch.bfloat16) if t.is_floating_point() else t)(torch.as_tensor(a)))
    def _A_setup():
        B, Sq, D = 8, 1, 448
        H, Sk, Dh = 16, 4096, 256
        return {
            "x": _w((lambda *s: torch.randn(*s, dtype=torch.bfloat16) * 0.05)(B, Sq, D)),
            "k_cache": _w((lambda *s: torch.randn(*s, dtype=torch.bfloat16) * 3.2)(B, H, Sk, Dh)),
            "v_cache": _w((lambda *s: torch.randn(*s, dtype=torch.bfloat16) * 1.6)(B, H, Sk, Dh)),
            "wq": _w((lambda *s: torch.randn(*s, dtype=torch.bfloat16) * 3.2)(D, H * Dh) * (D ** -0.5)),
            "wo": _w((lambda *s: torch.randn(*s, dtype=torch.bfloat16) * 1.6)(H * Dh, D) * ((H * Dh) ** -0.5)),
        }
    _A_in = _A_setup()

    def _B_setup():
        B, S, D, F = 8, 1, 448, 1792
        return {
            "x": _w((lambda *s: torch.randn(*s, dtype=torch.bfloat16) * 0.05)(B, S, D)),
            "w_gate": _w((lambda *s: torch.randn(*s, dtype=torch.bfloat16) * 0.4)(D, F)),
            "w_up": _w((lambda *s: torch.randn(*s, dtype=torch.bfloat16) * 0.05)(D, F)),
            "w_down": _w((lambda *s: torch.randn(*s, dtype=torch.bfloat16) * 0.05)(F, D)),
        }
    _B_in = _B_setup()

    return {
        "A_x": _A_in["x"],
        "A_k_cache": _A_in["k_cache"],
        "A_v_cache": _A_in["v_cache"],
        "A_wq": _A_in["wq"],
        "A_wo": _A_in["wo"],
        "B_x": _B_in["x"],
        "B_w_gate": _B_in["w_gate"],
        "B_w_up": _B_in["w_up"],
        "B_w_down": _B_in["w_down"],
    }

def reference(A_x, A_k_cache, A_v_cache, A_wq, A_wo, B_x, B_w_gate, B_w_up, B_w_down):
    def _A_ref(x, k_cache, v_cache, wq, wo):
        B, Sq, D = x.shape
        H, Dh = 16, 256
        q = (lambda x, *d: x.permute(*d))((x @ wq).reshape(B, Sq, H, Dh), 0, 2, 1, 3)
        scores = torch.einsum("bhqd,bhkd->bhqk", q, k_cache) * (Dh ** -0.5)
        p = _softmax(scores, axis=-1)
        o = torch.einsum("bhqk,bhkd->bhqd", p, v_cache)
        return (lambda x, *d: x.permute(*d))(o, 0, 2, 1, 3).reshape(B, Sq, H * Dh) @ wo

    def _B_ref(x, w_gate, w_up, w_down):
        g = torch.einsum("bsd,df->bsf", x, w_gate)
        u = torch.einsum("bsd,df->bsf", x, w_up)
        h = _sigmoid(g) * u
        return torch.einsum("bsf,fd->bsd", h, w_down)

    x = A_x
    xn = _layernorm(x, axis=-1)
    return x + _A_ref(xn, A_k_cache, A_v_cache, A_wq, A_wo) + _B_ref(xn, B_w_gate, B_w_up, B_w_down)
```

```asm
; @launch grid=(256,1,1) block=(512,1,1) lds=36864
.amdgcn_target "amdgcn-amd-amdhsa--gfx950"
.text
.globl parallel_sum__mha_block_cached__glu_gated_glu__decode_kernel
.p2align 8
.type parallel_sum__mha_block_cached__glu_gated_glu__decode_kernel,@function
parallel_sum__mha_block_cached__glu_gated_glu__decode_kernel:
    s_load_dwordx16 s[16:31], s[0:1], 0
    s_load_dwordx8 s[32:39], s[0:1], 64
    s_cmp_ge_u32 s2, 256
    s_cbranch_scc1 L_end
    s_and_b32 s3, s2, 7
    s_lshl_b32 s3, s3, 1
    s_bfe_u32 s14, s2, 0x10003
    s_or_b32 s3, s3, s14
    s_bfe_u32 s5, s2, 0x10004
    s_lshr_b32 s4, s2, 5
    s_lshl_b32 s8, s3, 1
    s_or_b32 s8, s8, s5
    s_lshl_b32 s6, s4, 5
    s_or_b32 s6, s6, s8
    s_lshl_b32 s14, s6, 20
    v_and_b32 v1, 63, v0
    v_lshrrev_b32 v2, 6, v0
    v_lshlrev_b32 v4, 4, v1
    v_readfirstlane_b32 s7, v2
    v_mul_u32_u24 v5, 896, v2
    v_add_u32 v5, v5, v4
    v_cmp_gt_u32 vcc, 56, v1
    v_mov_b32 v6, 0x40000000
    s_nop 0
    v_cndmask_b32 v5, v6, v5, vcc
    s_mov_b32 s54, 7168
    s_mov_b32 s55, 0x20000
    s_mov_b32 s46, 1048576
    s_mov_b32 s47, 0x20000
    v_lshrrev_b32 v6, 4, v0
    v_lshlrev_b32 v6, 16, v6
    v_and_b32 v7, 15, v0
    v_lshl_add_u32 v6, v7, 2, v6
    v_lshlrev_b32 v7, 18, v2
    v_add_u32 v6, v6, v7
    s_lshl_b32 s15, s5, 30
    v_add_u32 v6, s15, v6
    s_lshl_b32 s13, s3, 9
    s_lshl_b32 s15, s4, 6
    s_add_u32 s13, s13, s15
    s_sub_u32 s58, 3670016, s13
    s_mov_b32 s59, 0x20000
    s_and_b32 s15, s7, 3
    s_mul_i32 s15, s15, 4096
    s_lshr_b32 s100, s7, 2
    s_mul_i32 s100, s100, 524288
    s_add_u32 s15, s15, s100
    s_cmp_eq_u32 s7, 0
    s_cselect_b32 s15, 0x40000000, s15
    v_add_u32 v3, s15, v4
    s_cselect_b32 s99, 0, 0x40000000
    s_lshl_b32 s100, s4, 4
    s_add_u32 s100, s100, s3
    s_lshl_b32 s100, s100, 10
    s_add_u32 s100, s100, 1114112
    s_add_u32 s100, s100, s99
    s_lshl_b32 s101, s3, 10
    s_lshl_b32 s15, s4, 7
    s_add_u32 s101, s101, s15
    s_add_u32 s101, s101, 1114112
    s_lshl_b32 s15, s5, 30
    s_or_b32 s15, s15, s99
    s_add_u32 s101, s101, s15
    v_lshrrev_b32 v2, 3, v1
    v_lshlrev_b32 v2, 14, v2
    v_and_b32 v7, 7, v1
    v_lshl_add_u32 v2, v7, 4, v2
    s_mov_b32 s78, 1073741824
    s_mov_b32 s79, 0x20000
    s_waitcnt lgkmcnt(0)
    s_add_u32 s44, s18, s14
    s_addc_u32 s45, s19, 0
    s_mov_b32 s9, 0
    buffer_load_dwordx4 v[64:67], v3, s[44:47], s9 offen offset:0 nt
    buffer_load_dwordx4 v[68:71], v3, s[44:47], s9 offen offset:1024 nt
    buffer_load_dwordx4 v[72:75], v3, s[44:47], s9 offen offset:2048 nt
    buffer_load_dwordx4 v[76:79], v3, s[44:47], s9 offen offset:3072 nt
    s_mov_b32 s52, s16
    s_mov_b32 s53, s17
    buffer_load_dwordx4 v[8:11], v5, s[52:55], 0 offen
    s_mov_b32 s76, s38
    s_mov_b32 s77, s39
    buffer_load_dwordx4 v[244:247], v4, s[76:79], s100 offen sc1
    buffer_load_dwordx4 v[248:251], v2, s[76:79], s101 offen sc1
    s_add_u32 s56, s22, s13
    s_addc_u32 s57, s23, 0
    s_mov_b32 s13, 0
    s_movk_i32 s15, 0x2000
    buffer_load_dword v24, v6, s[56:59], s13 offen
    s_add_u32 s13, s13, s15
    buffer_load_dword v25, v6, s[56:59], s13 offen
    s_add_u32 s13, s13, s15
    buffer_load_dword v26, v6, s[56:59], s13 offen
    s_add_u32 s13, s13, s15
    buffer_load_dword v27, v6, s[56:59], s13 offen
    s_add_u32 s13, s13, s15
    buffer_load_dword v28, v6, s[56:59], s13 offen
    s_add_u32 s13, s13, s15
    buffer_load_dword v29, v6, s[56:59], s13 offen
    s_add_u32 s13, s13, s15
    buffer_load_dword v30, v6, s[56:59], s13 offen
    s_add_u32 s13, s13, s15
    buffer_load_dword v31, v6, s[56:59], s13 offen
    s_add_u32 s13, s13, 204800
    buffer_load_dword v32, v6, s[56:59], s13 offen
    s_add_u32 s13, s13, s15
    buffer_load_dword v33, v6, s[56:59], s13 offen
    s_add_u32 s13, s13, s15
    buffer_load_dword v34, v6, s[56:59], s13 offen
    s_add_u32 s13, s13, s15
    buffer_load_dword v35, v6, s[56:59], s13 offen
    s_add_u32 s13, s13, s15
    buffer_load_dword v36, v6, s[56:59], s13 offen
    s_add_u32 s13, s13, s15
    buffer_load_dword v37, v6, s[56:59], s13 offen
    s_add_u32 s13, s13, s15
    buffer_load_dword v38, v6, s[56:59], s13 offen
    s_add_u32 s13, s13, s15
    buffer_load_dword v39, v6, s[56:59], s13 offen
    s_add_u32 s48, s20, s14
    s_addc_u32 s49, s21, 0
    s_mov_b32 s21, 65536
    s_mov_b32 s10, 16384
    buffer_load_dwordx4 v[80:83], v3, s[44:47], s10 offen offset:0 nt
    buffer_load_dwordx4 v[84:87], v3, s[44:47], s10 offen offset:1024 nt
    buffer_load_dwordx4 v[88:91], v3, s[44:47], s10 offen offset:2048 nt
    buffer_load_dwordx4 v[92:95], v3, s[44:47], s10 offen offset:3072 nt
    s_mov_b32 s50, 1048576
    s_mov_b32 s51, 0x20000
    s_mul_i32 s14, s4, 896
    s_add_u32 s40, s16, s14
    s_addc_u32 s41, s17, 0
    s_mov_b32 s42, 896
    s_mov_b32 s43, 0x20000
    s_mul_i32 s14, s3, 229376
    s_add_u32 s60, s24, s14
    s_addc_u32 s61, s25, 0
    s_mov_b32 s62, 229376
    s_mov_b32 s63, 0x20000
    s_mul_i32 s14, s8, 112
    s_add_u32 s64, s28, s14
    s_addc_u32 s65, s29, 0
    s_sub_u32 s66, 1605632, s14
    s_mov_b32 s67, 0x20000
    s_add_u32 s68, s30, s14
    s_addc_u32 s69, s31, 0
    s_sub_u32 s70, 1605632, s14
    s_mov_b32 s71, 0x20000
    s_mul_i32 s14, s8, 50176
    s_add_u32 s72, s32, s14
    s_addc_u32 s73, s33, 0
    s_mov_b32 s74, 50176
    s_mov_b32 s75, 0x20000
    s_mov_b32 s80, s36
    s_mov_b32 s81, s37
    s_mov_b32 s82, 256
    s_mov_b32 s83, 0x20000
    s_mov_b32 s84, s34
    s_mov_b32 s85, s35
    s_mov_b32 s86, 7168
    s_mov_b32 s87, 0x20000
    s_mov_b32 s16, 0x05040100
    s_mov_b32 s17, 0x07060302
    s_mov_b32 s18, 0x3db8aa3b
    s_movk_i32 s20, 3584
    s_lshl_b32 s14, s7, 10
    v_add_u32 v62, s14, v4
    v_and_b32 v7, 31, v0
    v_lshlrev_b32 v7, 4, v7
    v_lshrrev_b32 v44, 3, v0
    v_mul_u32_u24 v60, 28672, v44
    v_and_b32 v47, 7, v0
    v_lshlrev_b32 v47, 4, v47
    v_add_u32 v60, v60, v47
    v_lshrrev_b32 v52, 3, v1
    s_lshl_b32 s15, s7, 7
    s_cmp_eq_u32 s7, 7
    s_cselect_b32 s15, 0x40000000, s15
    v_add_u32 v47, s15, v47
    v_mul_u32_u24 v53, 7168, v52
    v_add_u32 v53, v53, v47
    v_mul_u32_u24 v54, 28672, v52
    v_add_u32 v54, v54, v47
    v_lshlrev_b32 v55, 1, v7
    v_lshrrev_b32 v56, 5, v1
    v_lshl_add_u32 v55, v56, 4, v55
    v_add_u32 v55, s14, v55
    v_bfe_u32 v57, v1, 2, 3
    v_lshl_add_u32 v57, v56, 7, v57
    v_lshlrev_b32 v57, 2, v57
    v_add_u32 v57, s14, v57
    v_mov_b32 v58, 0xff800000
    v_and_b32 v61, 7, v1
    v_lshl_add_u32 v61, v61, 3, v52
    v_lshlrev_b32 v61, 2, v61
    s_lshl_b32 s15, s7, 8
    v_add_u32 v61, s15, v61
    s_waitcnt vmcnt(22)
    v_lshlrev_b32 v12, 16, v8
    v_and_b32 v13, 0xffff0000, v8
    v_lshlrev_b32 v14, 16, v9
    v_and_b32 v15, 0xffff0000, v9
    v_lshlrev_b32 v16, 16, v10
    v_and_b32 v17, 0xffff0000, v10
    v_lshlrev_b32 v18, 16, v11
    v_and_b32 v19, 0xffff0000, v11
    v_add_f32 v20, v12, v13
    v_add_f32 v20, v20, v14
    v_add_f32 v20, v20, v15
    v_add_f32 v20, v20, v16
    v_add_f32 v20, v20, v17
    v_add_f32 v20, v20, v18
    v_add_f32 v20, v20, v19
    s_nop 1
    v_add_f32_dpp v20, v20, v20 quad_perm:[1,0,3,2] row_mask:0xf bank_mask:0xf
    s_nop 1
    v_add_f32_dpp v20, v20, v20 quad_perm:[2,3,0,1] row_mask:0xf bank_mask:0xf
    s_nop 1
    v_add_f32_dpp v20, v20, v20 row_half_mirror row_mask:0xf bank_mask:0xf
    s_nop 1
    v_add_f32_dpp v20, v20, v20 row_mirror row_mask:0xf bank_mask:0xf
    v_mov_b32 v21, v20
    s_nop 1
    v_permlane16_swap_b32 v20, v21
    v_add_f32 v20, v20, v21
    v_mov_b32 v21, v20
    s_nop 1
    v_permlane32_swap_b32 v20, v21
    v_add_f32 v20, v20, v21
    v_mul_f32 v20, 0x3b124925, v20
    v_mov_b32 v22, 0
    v_sub_f32 v23, v12, v20
    v_fmac_f32 v22, v23, v23
    v_sub_f32 v23, v13, v20
    v_fmac_f32 v22, v23, v23
    v_sub_f32 v23, v14, v20
    v_fmac_f32 v22, v23, v23
    v_sub_f32 v23, v15, v20
    v_fmac_f32 v22, v23, v23
    v_sub_f32 v23, v16, v20
    v_fmac_f32 v22, v23, v23
    v_sub_f32 v23, v17, v20
    v_fmac_f32 v22, v23, v23
    v_sub_f32 v23, v18, v20
    v_fmac_f32 v22, v23, v23
    v_sub_f32 v23, v19, v20
    v_fmac_f32 v22, v23, v23
    v_cndmask_b32 v22, 0, v22, vcc
    s_nop 1
    v_add_f32_dpp v22, v22, v22 quad_perm:[1,0,3,2] row_mask:0xf bank_mask:0xf
    s_nop 1
    v_add_f32_dpp v22, v22, v22 quad_perm:[2,3,0,1] row_mask:0xf bank_mask:0xf
    s_nop 1
    v_add_f32_dpp v22, v22, v22 row_half_mirror row_mask:0xf bank_mask:0xf
    s_nop 1
    v_add_f32_dpp v22, v22, v22 row_mirror row_mask:0xf bank_mask:0xf
    v_mov_b32 v21, v22
    s_nop 1
    v_permlane16_swap_b32 v22, v21
    v_add_f32 v22, v22, v21
    v_mov_b32 v21, v22
    s_nop 1
    v_permlane32_swap_b32 v22, v21
    v_add_f32 v22, v22, v21
    v_mul_f32 v22, 0x3b124925, v22
    v_cvt_pk_bf16_f32 v22, v22, v22
    v_lshlrev_b32 v22, 16, v22
    v_add_f32 v22, 0x3727c5ac, v22
    v_cvt_pk_bf16_f32 v22, v22, v22
    v_lshlrev_b32 v22, 16, v22
    v_sqrt_f32 v22, v22
    s_nop 0
    v_cvt_pk_bf16_f32 v22, v22, v22
    v_lshlrev_b32 v22, 16, v22
    v_rcp_f32 v23, v22
    v_cvt_pk_bf16_f32 v20, v20, v20
    v_lshlrev_b32 v20, 16, v20
    v_sub_f32 v12, v12, v20
    v_cvt_pk_bf16_f32 v12, v12, v12
    v_lshlrev_b32 v12, 16, v12
    v_mul_f32 v8, v12, v23
    v_fma_f32 v9, -v8, v22, v12
    v_fma_f32 v12, v9, v23, v8
    v_sub_f32 v13, v13, v20
    v_cvt_pk_bf16_f32 v13, v13, v13
    v_lshlrev_b32 v13, 16, v13
    v_mul_f32 v8, v13, v23
    v_fma_f32 v9, -v8, v22, v13
    v_fma_f32 v13, v9, v23, v8
    v_sub_f32 v14, v14, v20
    v_cvt_pk_bf16_f32 v14, v14, v14
    v_lshlrev_b32 v14, 16, v14
    v_mul_f32 v8, v14, v23
    v_fma_f32 v9, -v8, v22, v14
    v_fma_f32 v14, v9, v23, v8
    v_sub_f32 v15, v15, v20
    v_cvt_pk_bf16_f32 v15, v15, v15
    v_lshlrev_b32 v15, 16, v15
    v_mul_f32 v8, v15, v23
    v_fma_f32 v9, -v8, v22, v15
    v_fma_f32 v15, v9, v23, v8
    v_sub_f32 v16, v16, v20
    v_cvt_pk_bf16_f32 v16, v16, v16
    v_lshlrev_b32 v16, 16, v16
    v_mul_f32 v8, v16, v23
    v_fma_f32 v9, -v8, v22, v16
    v_fma_f32 v16, v9, v23, v8
    v_sub_f32 v17, v17, v20
    v_cvt_pk_bf16_f32 v17, v17, v17
    v_lshlrev_b32 v17, 16, v17
    v_mul_f32 v8, v17, v23
    v_fma_f32 v9, -v8, v22, v17
    v_fma_f32 v17, v9, v23, v8
    v_sub_f32 v18, v18, v20
    v_cvt_pk_bf16_f32 v18, v18, v18
    v_lshlrev_b32 v18, 16, v18
    v_mul_f32 v8, v18, v23
    v_fma_f32 v9, -v8, v22, v18
    v_fma_f32 v18, v9, v23, v8
    v_sub_f32 v19, v19, v20
    v_cvt_pk_bf16_f32 v19, v19, v19
    v_lshlrev_b32 v19, 16, v19
    v_mul_f32 v8, v19, v23
    v_fma_f32 v9, -v8, v22, v19
    v_fma_f32 v19, v9, v23, v8
    v_cvt_pk_bf16_f32 v8, v12, v13
    v_cvt_pk_bf16_f32 v9, v14, v15
    v_cvt_pk_bf16_f32 v10, v16, v17
    v_cvt_pk_bf16_f32 v11, v18, v19
    ds_write_b128 v62, v[8:11] offset:0
    s_lshl_b32 s15, s7, 2
    v_mov_b32 v13, s15
    v_mov_b32 v12, 0
    ds_write_b32 v13, v12 offset:29824
    v_and_b32 v5, 7, v1
    v_lshlrev_b32 v5, 10, v5
    v_lshrrev_b32 v6, 4, v1
    v_lshl_add_u32 v5, v6, 4, v5
    s_lshl_b32 s15, s7, 7
    v_add_u32 v5, s15, v5
    s_lshl_b32 s15, s4, 10
    v_lshlrev_b32 v45, 4, v44
    v_add_u32 v45, s15, v45
    v_lshlrev_b32 v6, 9, v6
    v_and_b32 v14, 15, v1
    v_lshl_add_u32 v6, v14, 3, v6
    s_add_u32 s15, s14, 8192
    v_add_u32 v6, s15, v6
    s_mov_b32 s11, 32768
    buffer_load_dwordx4 v[96:99], v3, s[44:47], s11 offen offset:0 nt
    buffer_load_dwordx4 v[100:103], v3, s[44:47], s11 offen offset:1024 nt
    s_waitcnt lgkmcnt(0)
    s_barrier
    ds_read_b128 v[16:19], v5 offset:0
    ds_read_b128 v[20:23], v5 offset:64
    ds_read_b128 v[48:51], v45 offset:0
    s_waitcnt vmcnt(14) lgkmcnt(0)
    v_perm_b32 v8, v25, v24, s16
    v_perm_b32 v12, v25, v24, s17
    v_perm_b32 v9, v27, v26, s16
    v_perm_b32 v13, v27, v26, s17
    v_perm_b32 v10, v29, v28, s16
    v_perm_b32 v14, v29, v28, s17
    v_perm_b32 v11, v31, v30, s16
    v_perm_b32 v15, v31, v30, s17
    s_nop 0
    v_mfma_f32_16x16x32_bf16 v[44:47], v[16:19], v[8:11], 0
    v_mfma_f32_16x16x32_bf16 v[40:43], v[16:19], v[12:15], 0
    s_waitcnt vmcnt(6)
    v_perm_b32 v24, v33, v32, s16
    v_perm_b32 v28, v33, v32, s17
    v_perm_b32 v25, v35, v34, s16
    v_perm_b32 v29, v35, v34, s17
    v_perm_b32 v26, v37, v36, s16
    v_perm_b32 v30, v37, v36, s17
    v_perm_b32 v27, v39, v38, s16
    v_perm_b32 v31, v39, v38, s17
    s_nop 0
    v_mfma_f32_16x16x32_bf16 v[44:47], v[20:23], v[24:27], v[44:47]
    v_mfma_f32_16x16x32_bf16 v[40:43], v[20:23], v[28:31], v[40:43]
    s_mov_b32 exec_lo, -1
    s_mov_b32 exec_hi, 0
    s_nop 5
    ds_write2_b32 v6, v44, v40 offset0:0 offset1:1
    ds_write2_b32 v6, v45, v41 offset0:32 offset1:33
    ds_write2_b32 v6, v46, v42 offset0:64 offset1:65
    ds_write2_b32 v6, v47, v43 offset0:96 offset1:97
    s_mov_b64 exec, -1
    s_waitcnt lgkmcnt(0)
    s_barrier
    s_cmp_eq_u32 s7, 0
    s_cbranch_scc1 L_comm
    buffer_load_dwordx4 v[104:107], v3, s[44:47], s11 offen offset:2048 nt
    buffer_load_dwordx4 v[108:111], v3, s[44:47], s11 offen offset:3072 nt
    s_mov_b32 s12, 49152
    buffer_load_dwordx4 v[112:115], v3, s[44:47], s12 offen offset:0 nt
    buffer_load_dwordx4 v[116:119], v3, s[44:47], s12 offen offset:1024 nt
    buffer_load_dwordx4 v[120:123], v3, s[44:47], s12 offen offset:2048 nt
    buffer_load_dwordx4 v[124:127], v3, s[44:47], s12 offen offset:3072 nt
    s_add_u32 s9, s9, s21
    buffer_load_dwordx4 v[160:163], v3, s[44:47], s9 offen offset:0 nt
    buffer_load_dwordx4 v[164:167], v3, s[44:47], s9 offen offset:1024 nt
    buffer_load_dwordx4 v[168:171], v3, s[44:47], s9 offen offset:2048 nt
    buffer_load_dwordx4 v[172:175], v3, s[44:47], s9 offen offset:3072 nt
    s_add_u32 s10, s10, s21
    buffer_load_dwordx4 v[176:179], v3, s[44:47], s10 offen offset:0 nt
    buffer_load_dwordx4 v[180:183], v3, s[44:47], s10 offen offset:1024 nt
    buffer_load_dwordx4 v[184:187], v3, s[44:47], s10 offen offset:2048 nt
    buffer_load_dwordx4 v[188:191], v3, s[44:47], s10 offen offset:3072 nt
    s_add_u32 s11, s11, s21
    buffer_load_dwordx4 v[192:195], v3, s[44:47], s11 offen offset:0 nt
    buffer_load_dwordx4 v[196:199], v3, s[44:47], s11 offen offset:1024 nt
    buffer_load_dwordx4 v[200:203], v3, s[44:47], s11 offen offset:2048 nt
    buffer_load_dwordx4 v[204:207], v3, s[44:47], s11 offen offset:3072 nt
    s_add_u32 s12, s12, s21
    buffer_load_dwordx4 v[208:211], v3, s[44:47], s12 offen offset:0 nt
    buffer_load_dwordx4 v[212:215], v3, s[44:47], s12 offen offset:1024 nt
    buffer_load_dwordx4 v[216:219], v3, s[44:47], s12 offen offset:2048 nt
    buffer_load_dwordx4 v[220:223], v3, s[44:47], s12 offen offset:3072 nt
    s_add_u32 s9, s9, s21
    buffer_load_dwordx4 v[224:227], v3, s[44:47], s9 offen offset:0 nt
    buffer_load_dwordx4 v[228:231], v3, s[44:47], s9 offen offset:1024 nt
    buffer_load_dwordx4 v[232:235], v3, s[44:47], s9 offen offset:2048 nt
    buffer_load_dwordx4 v[236:239], v3, s[44:47], s9 offen offset:3072 nt
    s_add_u32 s10, s10, s21
    buffer_load_dwordx4 v[240:243], v3, s[44:47], s10 offen offset:0 nt
    buffer_load_dwordx4 v[244:247], v3, s[44:47], s10 offen offset:1024 nt
    buffer_load_dwordx4 v[248:251], v3, s[44:47], s10 offen offset:2048 nt
    buffer_load_dwordx4 v[252:255], v3, s[44:47], s10 offen offset:3072 nt
    s_barrier
    s_branch L_afterq
L_comm:
    ds_read_b128 v[8:11], v4 offset:8192
    ds_read_b128 v[12:15], v4 offset:9216
    ds_read_b128 v[16:19], v4 offset:10240
    ds_read_b128 v[20:23], v4 offset:11264
    ds_read_b128 v[24:27], v4 offset:12288
    ds_read_b128 v[28:31], v4 offset:13312
    ds_read_b128 v[32:35], v4 offset:14336
    s_waitcnt vmcnt(0) lgkmcnt(0)
    v_add_f32 v8, v8, v12
    v_add_f32 v9, v9, v13
    v_add_f32 v10, v10, v14
    v_add_f32 v11, v11, v15
    v_add_f32 v8, v8, v16
    v_add_f32 v9, v9, v17
    v_add_f32 v10, v10, v18
    v_add_f32 v11, v11, v19
    v_add_f32 v8, v8, v20
    v_add_f32 v9, v9, v21
    v_add_f32 v10, v10, v22
    v_add_f32 v11, v11, v23
    v_add_f32 v8, v8, v24
    v_add_f32 v9, v9, v25
    v_add_f32 v10, v10, v26
    v_add_f32 v11, v11, v27
    v_add_f32 v8, v8, v28
    v_add_f32 v9, v9, v29
    v_add_f32 v10, v10, v30
    v_add_f32 v11, v11, v31
    v_add_f32 v8, v8, v32
    v_add_f32 v9, v9, v33
    v_add_f32 v10, v10, v34
    v_add_f32 v11, v11, v35
    v_cvt_pk_bf16_f32 v8, v8, v9
    v_cvt_pk_bf16_f32 v10, v10, v11
    v_add_u32 v9, 1, v249
    v_add_u32 v11, 1, v251
    buffer_store_dwordx4 v[8:11], v2, s[76:79], s101 offen sc1
    v_add_u32 v16, 1, v245
    v_add_u32 v17, 1, v247
    v_mov_b32 v18, 0
    v_lshlrev_b32 v19, 3, v1
    s_mov_b32 s13, 0
    s_nop 2
L_poll:
    buffer_load_dwordx4 v[12:15], v4, s[76:79], s100 offen sc1
    s_add_u32 s13, s13, 1
    s_waitcnt vmcnt(0)
    v_cmp_eq_u32 s[26:27], v13, v16
    v_cmp_eq_u32 s[28:29], v15, v17
    s_nop 1
    s_and_b64 s[26:27], s[26:27], s[28:29]
    s_cmp_eq_u64 s[26:27], -1
    s_cbranch_scc1 L_got
    s_sleep 4
    s_cmp_lt_u32 s13, 24
    s_cbranch_scc1 L_poll
    v_mov_b32 v10, 1
    ds_write_b32 v18, v10 offset:29760
    s_branch L_commdone
L_got:
    ds_write_b32 v18, v18 offset:29760
    v_add_u32 v19, 16384, v19
    ds_write2_b32 v19, v12, v14 offset0:0 offset1:1
L_commdone:
    v_mov_b32 v3, v4
    s_waitcnt lgkmcnt(0)
    s_barrier
    s_mov_b32 s9, 0
    buffer_load_dwordx4 v[64:67], v3, s[44:47], s9 offen offset:0 nt
    buffer_load_dwordx4 v[68:71], v3, s[44:47], s9 offen offset:1024 nt
    buffer_load_dwordx4 v[72:75], v3, s[44:47], s9 offen offset:2048 nt
    buffer_load_dwordx4 v[76:79], v3, s[44:47], s9 offen offset:3072 nt
    s_mov_b32 s10, 16384
    buffer_load_dwordx4 v[80:83], v3, s[44:47], s10 offen offset:0 nt
    buffer_load_dwordx4 v[84:87], v3, s[44:47], s10 offen offset:1024 nt
    buffer_load_dwordx4 v[88:91], v3, s[44:47], s10 offen offset:2048 nt
    buffer_load_dwordx4 v[92:95], v3, s[44:47], s10 offen offset:3072 nt
    s_mov_b32 s11, 32768
    buffer_load_dwordx4 v[96:99], v3, s[44:47], s11 offen offset:0 nt
    buffer_load_dwordx4 v[100:103], v3, s[44:47], s11 offen offset:1024 nt
    buffer_load_dwordx4 v[104:107], v3, s[44:47], s11 offen offset:2048 nt
    buffer_load_dwordx4 v[108:111], v3, s[44:47], s11 offen offset:3072 nt
    s_mov_b32 s12, 49152
    buffer_load_dwordx4 v[112:115], v3, s[44:47], s12 offen offset:0 nt
    buffer_load_dwordx4 v[116:119], v3, s[44:47], s12 offen offset:1024 nt
    buffer_load_dwordx4 v[120:123], v3, s[44:47], s12 offen offset:2048 nt
    buffer_load_dwordx4 v[124:127], v3, s[44:47], s12 offen offset:3072 nt
    s_add_u32 s9, s9, s21
    buffer_load_dwordx4 v[160:163], v3, s[44:47], s9 offen offset:0 nt
    buffer_load_dwordx4 v[164:167], v3, s[44:47], s9 offen offset:1024 nt
    buffer_load_dwordx4 v[168:171], v3, s[44:47], s9 offen offset:2048 nt
    buffer_load_dwordx4 v[172:175], v3, s[44:47], s9 offen offset:3072 nt
    s_add_u32 s10, s10, s21
    buffer_load_dwordx4 v[176:179], v3, s[44:47], s10 offen offset:0 nt
    buffer_load_dwordx4 v[180:183], v3, s[44:47], s10 offen offset:1024 nt
    buffer_load_dwordx4 v[184:187], v3, s[44:47], s10 offen offset:2048 nt
    buffer_load_dwordx4 v[188:191], v3, s[44:47], s10 offen offset:3072 nt
    s_add_u32 s11, s11, s21
    buffer_load_dwordx4 v[192:195], v3, s[44:47], s11 offen offset:0 nt
    buffer_load_dwordx4 v[196:199], v3, s[44:47], s11 offen offset:1024 nt
    buffer_load_dwordx4 v[200:203], v3, s[44:47], s11 offen offset:2048 nt
    buffer_load_dwordx4 v[204:207], v3, s[44:47], s11 offen offset:3072 nt
    s_add_u32 s12, s12, s21
    buffer_load_dwordx4 v[208:211], v3, s[44:47], s12 offen offset:0 nt
    buffer_load_dwordx4 v[212:215], v3, s[44:47], s12 offen offset:1024 nt
    buffer_load_dwordx4 v[216:219], v3, s[44:47], s12 offen offset:2048 nt
    buffer_load_dwordx4 v[220:223], v3, s[44:47], s12 offen offset:3072 nt
    s_add_u32 s9, s9, s21
    buffer_load_dwordx4 v[224:227], v3, s[44:47], s9 offen offset:0 nt
    buffer_load_dwordx4 v[228:231], v3, s[44:47], s9 offen offset:1024 nt
    buffer_load_dwordx4 v[232:235], v3, s[44:47], s9 offen offset:2048 nt
    buffer_load_dwordx4 v[236:239], v3, s[44:47], s9 offen offset:3072 nt
    s_add_u32 s10, s10, s21
    buffer_load_dwordx4 v[240:243], v3, s[44:47], s10 offen offset:0 nt
    buffer_load_dwordx4 v[244:247], v3, s[44:47], s10 offen offset:1024 nt
    buffer_load_dwordx4 v[248:251], v3, s[44:47], s10 offen offset:2048 nt
    buffer_load_dwordx4 v[252:255], v3, s[44:47], s10 offen offset:3072 nt
L_afterq:
    v_mov_b32 v46, 0
    ds_read_b32 v45, v46 offset:29760
    ds_read_b128 v[8:11], v7 offset:16384
    s_mov_b32 s19, 0
    s_waitcnt lgkmcnt(0)
    v_readfirstlane_b32 s14, v45
    s_nop 1
    s_cmp_eq_u32 s14, 0
    s_cbranch_scc1 L_kgo
    s_lshl_b32 s14, s3, 9
    s_add_u32 s56, s22, s14
    s_addc_u32 s57, s23, 0
    s_sub_u32 s58, 3670016, s14
    v_lshrrev_b32 v5, 5, v0
    v_mul_u32_u24 v6, 229376, v5
    v_add_u32 v6, v6, v7
    v_mul_u32_u24 v5, 56, v5
    s_lshl_b32 s15, s4, 10
    v_add_u32 v5, s15, v5
    v_mov_b32 v8, 0
    v_mov_b32 v9, 0
    v_mov_b32 v10, 0
    v_mov_b32 v11, 0
    v_mov_b32 v12, 0
    v_mov_b32 v13, 0
    v_mov_b32 v14, 0
    v_mov_b32 v15, 0
    s_mov_b32 s13, 0
    s_mov_b32 s14, 0
    s_nop 1
L_fb:
    buffer_load_dwordx4 v[24:27], v6, s[56:59], s14 offen
    s_add_u32 s14, s14, 8192
    buffer_load_dwordx4 v[28:31], v6, s[56:59], s14 offen
    s_add_u32 s14, s14, 8192
    ds_read_b32 v32, v5 offset:0
    v_add_u32 v5, 4, v5
    s_waitcnt vmcnt(0) lgkmcnt(0)
    v_perm_b32 v16, v28, v24, s16
    v_perm_b32 v17, v28, v24, s17
    v_perm_b32 v18, v29, v25, s16
    v_perm_b32 v19, v29, v25, s17
    v_perm_b32 v20, v30, v26, s16
    v_perm_b32 v21, v30, v26, s17
    v_perm_b32 v22, v31, v27, s16
    v_perm_b32 v23, v31, v27, s17
    v_dot2_f32_bf16 v8, v16, v32, v8
    v_dot2_f32_bf16 v9, v17, v32, v9
    v_dot2_f32_bf16 v10, v18, v32, v10
    v_dot2_f32_bf16 v11, v19, v32, v11
    v_dot2_f32_bf16 v12, v20, v32, v12
    v_dot2_f32_bf16 v13, v21, v32, v13
    v_dot2_f32_bf16 v14, v22, v32, v14
    v_dot2_f32_bf16 v15, v23, v32, v15
    s_add_u32 s13, s13, 1
    s_cmp_lt_u32 s13, 14
    s_nop 1
    s_cbranch_scc1 L_fb
    v_permlane32_swap_b32 v8, v12
    v_permlane32_swap_b32 v9, v13
    v_permlane32_swap_b32 v10, v14
    v_permlane32_swap_b32 v11, v15
    v_add_f32 v8, v8, v12
    v_add_f32 v9, v9, v13
    v_add_f32 v10, v10, v14
    v_add_f32 v11, v11, v15
    ds_write_b128 v55, v[8:11] offset:8192
    s_waitcnt lgkmcnt(0)
    s_barrier
    s_cmp_ge_u32 s7, 2
    s_cbranch_scc1 L_sp621
    v_lshlrev_b32 v16, 3, v0
    ds_read_b64 v[24:25], v16 offset:8192
    ds_read_b64 v[26:27], v16 offset:9216
    ds_read_b64 v[28:29], v16 offset:10240
    ds_read_b64 v[30:31], v16 offset:11264
    ds_read_b64 v[32:33], v16 offset:12288
    ds_read_b64 v[34:35], v16 offset:13312
    ds_read_b64 v[36:37], v16 offset:14336
    ds_read_b64 v[38:39], v16 offset:15360
    s_waitcnt lgkmcnt(0)
    v_add_f32 v24, v24, v26
    v_add_f32 v25, v25, v27
    v_add_f32 v24, v24, v28
    v_add_f32 v25, v25, v29
    v_add_f32 v24, v24, v30
    v_add_f32 v25, v25, v31
    v_add_f32 v24, v24, v32
    v_add_f32 v25, v25, v33
    v_add_f32 v24, v24, v34
    v_add_f32 v25, v25, v35
    v_add_f32 v24, v24, v36
    v_add_f32 v25, v25, v37
    v_add_f32 v24, v24, v38
    v_add_f32 v25, v25, v39
    v_cvt_pk_bf16_f32 v24, v24, v25
    v_lshlrev_b32 v16, 2, v0
    ds_write_b32 v16, v24 offset:16384
    s_waitcnt lgkmcnt(0)
    s_nop 1
L_sp621:
    s_barrier
    ds_read_b128 v[8:11], v7 offset:16384
    s_waitcnt lgkmcnt(0)
L_kgo:
    s_waitcnt vmcnt(39)
    v_dot2_f32_bf16 v16, v64, v8, 0
    v_dot2_f32_bf16 v16, v65, v9, v16
    v_dot2_f32_bf16 v16, v66, v10, v16
    v_dot2_f32_bf16 v16, v67, v11, v16
    s_add_u32 s11, s11, s21
    buffer_load_dwordx4 v[64:67], v3, s[44:47], s11 offen offset:0 nt
    s_waitcnt vmcnt(39)
    v_dot2_f32_bf16 v17, v68, v8, 0
    v_dot2_f32_bf16 v17, v69, v9, v17
    v_dot2_f32_bf16 v17, v70, v10, v17
    v_dot2_f32_bf16 v17, v71, v11, v17
    buffer_load_dwordx4 v[68:71], v3, s[44:47], s11 offen offset:1024 nt
    s_waitcnt vmcnt(39)
    v_dot2_f32_bf16 v18, v72, v8, 0
    v_dot2_f32_bf16 v18, v73, v9, v18
    v_dot2_f32_bf16 v18, v74, v10, v18
    v_dot2_f32_bf16 v18, v75, v11, v18
    buffer_load_dwordx4 v[72:75], v3, s[44:47], s11 offen offset:2048 nt
    s_waitcnt vmcnt(39)
    v_dot2_f32_bf16 v19, v76, v8, 0
    v_dot2_f32_bf16 v19, v77, v9, v19
    v_dot2_f32_bf16 v19, v78, v10, v19
    v_dot2_f32_bf16 v19, v79, v11, v19
    buffer_load_dwordx4 v[76:79], v3, s[44:47], s11 offen offset:3072 nt
    s_waitcnt vmcnt(39)
    v_dot2_f32_bf16 v20, v80, v8, 0
    v_dot2_f32_bf16 v20, v81, v9, v20
    v_dot2_f32_bf16 v20, v82, v10, v20
    v_dot2_f32_bf16 v20, v83, v11, v20
    s_add_u32 s12, s12, s21
    buffer_load_dwordx4 v[80:83], v3, s[44:47], s12 offen offset:0 nt
    s_waitcnt vmcnt(39)
    v_dot2_f32_bf16 v21, v84, v8, 0
    v_dot2_f32_bf16 v21, v85, v9, v21
    v_dot2_f32_bf16 v21, v86, v10, v21
    v_dot2_f32_bf16 v21, v87, v11, v21
    buffer_load_dwordx4 v[84:87], v3, s[44:47], s12 offen offset:1024 nt
    s_waitcnt vmcnt(39)
    v_dot2_f32_bf16 v22, v88, v8, 0
    v_dot2_f32_bf16 v22, v89, v9, v22
    v_dot2_f32_bf16 v22, v90, v10, v22
    v_dot2_f32_bf16 v22, v91, v11, v22
    buffer_load_dwordx4 v[88:91], v3, s[44:47], s12 offen offset:2048 nt
    s_waitcnt vmcnt(39)
    v_dot2_f32_bf16 v23, v92, v8, 0
    v_dot2_f32_bf16 v23, v93, v9, v23
    v_dot2_f32_bf16 v23, v94, v10, v23
    v_dot2_f32_bf16 v23, v95, v11, v23
    buffer_load_dwordx4 v[92:95], v3, s[44:47], s12 offen offset:3072 nt
    v_permlane16_swap_b32 v16, v20
    v_permlane16_swap_b32 v17, v21
    v_permlane16_swap_b32 v18, v22
    v_permlane16_swap_b32 v19, v23
    v_add_f32 v16, v16, v20
    v_add_f32 v17, v17, v21
    v_add_f32 v18, v18, v22
    v_add_f32 v19, v19, v23
    v_add_f32_dpp v20, v16, v16 row_ror:8 row_mask:0xf bank_mask:0x3
    v_add_f32_dpp v20, v18, v18 row_ror:8 row_mask:0xf bank_mask:0xc
    v_add_f32_dpp v21, v17, v17 row_ror:8 row_mask:0xf bank_mask:0x3
    v_add_f32_dpp v21, v19, v19 row_ror:8 row_mask:0xf bank_mask:0xc
    v_add_f32_dpp v16, v20, v20 row_half_mirror row_mask:0xf bank_mask:0x5
    s_nop 0
    v_add_f32_dpp v16, v21, v21 row_half_mirror row_mask:0xf bank_mask:0xa
    s_nop 1
    v_add_f32_dpp v16, v16, v16 quad_perm:[1,0,3,2] row_mask:0xf bank_mask:0xf
    s_nop 1
    v_add_f32_dpp v16, v16, v16 quad_perm:[2,3,0,1] row_mask:0xf bank_mask:0xf
    ds_write_b32 v57, v16 offset:17408
    v_max_f32 v58, v58, v16
    s_waitcnt vmcnt(39)
    v_dot2_f32_bf16 v16, v96, v8, 0
    v_dot2_f32_bf16 v16, v97, v9, v16
    v_dot2_f32_bf16 v16, v98, v10, v16
    v_dot2_f32_bf16 v16, v99, v11, v16
    s_add_u32 s9, s9, s21
    buffer_load_dwordx4 v[96:99], v3, s[44:47], s9 offen offset:0 nt
    s_waitcnt vmcnt(39)
    v_dot2_f32_bf16 v17, v100, v8, 0
    v_dot2_f32_bf16 v17, v101, v9, v17
    v_dot2_f32_bf16 v17, v102, v10, v17
    v_dot2_f32_bf16 v17, v103, v11, v17
    buffer_load_dwordx4 v[100:103], v3, s[44:47], s9 offen offset:1024 nt
    s_waitcnt vmcnt(39)
    v_dot2_f32_bf16 v18, v104, v8, 0
    v_dot2_f32_bf16 v18, v105, v9, v18
    v_dot2_f32_bf16 v18, v106, v10, v18
    v_dot2_f32_bf16 v18, v107, v11, v18
    buffer_load_dwordx4 v[104:107], v3, s[44:47], s9 offen offset:2048 nt
    s_waitcnt vmcnt(39)
    v_dot2_f32_bf16 v19, v108, v8, 0
    v_dot2_f32_bf16 v19, v109, v9, v19
    v_dot2_f32_bf16 v19, v110, v10, v19
    v_dot2_f32_bf16 v19, v111, v11, v19
    buffer_load_dwordx4 v[108:111], v3, s[44:47], s9 offen offset:3072 nt
    s_waitcnt vmcnt(39)
    v_dot2_f32_bf16 v20, v112, v8, 0
    v_dot2_f32_bf16 v20, v113, v9, v20
    v_dot2_f32_bf16 v20, v114, v10, v20
    v_dot2_f32_bf16 v20, v115, v11, v20
    s_add_u32 s10, s10, s21
    buffer_load_dwordx4 v[112:115], v3, s[44:47], s10 offen offset:0 nt
    s_waitcnt vmcnt(39)
    v_dot2_f32_bf16 v21, v116, v8, 0
    v_dot2_f32_bf16 v21, v117, v9, v21
    v_dot2_f32_bf16 v21, v118, v10, v21
    v_dot2_f32_bf16 v21, v119, v11, v21
    buffer_load_dwordx4 v[116:119], v3, s[44:47], s10 offen offset:1024 nt
    s_waitcnt vmcnt(39)
    v_dot2_f32_bf16 v22, v120, v8, 0
    v_dot2_f32_bf16 v22, v121, v9, v22
    v_dot2_f32_bf16 v22, v122, v10, v22
    v_dot2_f32_bf16 v22, v123, v11, v22
    buffer_load_dwordx4 v[120:123], v3, s[44:47], s10 offen offset:2048 nt
    s_waitcnt vmcnt(39)
    v_dot2_f32_bf16 v23, v124, v8, 0
    v_dot2_f32_bf16 v23, v125, v9, v23
    v_dot2_f32_bf16 v23, v126, v10, v23
    v_dot2_f32_bf16 v23, v127, v11, v23
    buffer_load_dwordx4 v[124:127], v3, s[44:47], s10 offen offset:3072 nt
    v_permlane16_swap_b32 v16, v20
    v_permlane16_swap_b32 v17, v21
    v_permlane16_swap_b32 v18, v22
    v_permlane16_swap_b32 v19, v23
    v_add_f32 v16, v16, v20
    v_add_f32 v17, v17, v21
    v_add_f32 v18, v18, v22
    v_add_f32 v19, v19, v23
    v_add_f32_dpp v20, v16, v16 row_ror:8 row_mask:0xf bank_mask:0x3
    v_add_f32_dpp v20, v18, v18 row_ror:8 row_mask:0xf bank_mask:0xc
    v_add_f32_dpp v21, v17, v17 row_ror:8 row_mask:0xf bank_mask:0x3
    v_add_f32_dpp v21, v19, v19 row_ror:8 row_mask:0xf bank_mask:0xc
    v_add_f32_dpp v16, v20, v20 row_half_mirror row_mask:0xf bank_mask:0x5
    s_nop 0
    v_add_f32_dpp v16, v21, v21 row_half_mirror row_mask:0xf bank_mask:0xa
    s_nop 1
    v_add_f32_dpp v16, v16, v16 quad_perm:[1,0,3,2] row_mask:0xf bank_mask:0xf
    s_nop 1
    v_add_f32_dpp v16, v16, v16 quad_perm:[2,3,0,1] row_mask:0xf bank_mask:0xf
    ds_write_b32 v57, v16 offset:17440
    v_max_f32 v58, v58, v16
    s_waitcnt vmcnt(39)
    v_dot2_f32_bf16 v16, v160, v8, 0
    v_dot2_f32_bf16 v16, v161, v9, v16
    v_dot2_f32_bf16 v16, v162, v10, v16
    v_dot2_f32_bf16 v16, v163, v11, v16
    s_waitcnt vmcnt(38)
    v_dot2_f32_bf16 v17, v164, v8, 0
    v_dot2_f32_bf16 v17, v165, v9, v17
    v_dot2_f32_bf16 v17, v166, v10, v17
    v_dot2_f32_bf16 v17, v167, v11, v17
    s_waitcnt vmcnt(37)
    v_dot2_f32_bf16 v18, v168, v8, 0
    v_dot2_f32_bf16 v18, v169, v9, v18
    v_dot2_f32_bf16 v18, v170, v10, v18
    v_dot2_f32_bf16 v18, v171, v11, v18
    s_waitcnt vmcnt(36)
    v_dot2_f32_bf16 v19, v172, v8, 0
    v_dot2_f32_bf16 v19, v173, v9, v19
    v_dot2_f32_bf16 v19, v174, v10, v19
    v_dot2_f32_bf16 v19, v175, v11, v19
    s_waitcnt vmcnt(35)
    v_dot2_f32_bf16 v20, v176, v8, 0
    v_dot2_f32_bf16 v20, v177, v9, v20
    v_dot2_f32_bf16 v20, v178, v10, v20
    v_dot2_f32_bf16 v20, v179, v11, v20
    s_waitcnt vmcnt(34)
    v_dot2_f32_bf16 v21, v180, v8, 0
    v_dot2_f32_bf16 v21, v181, v9, v21
    v_dot2_f32_bf16 v21, v182, v10, v21
    v_dot2_f32_bf16 v21, v183, v11, v21
    s_waitcnt vmcnt(33)
    v_dot2_f32_bf16 v22, v184, v8, 0
    v_dot2_f32_bf16 v22, v185, v9, v22
    v_dot2_f32_bf16 v22, v186, v10, v22
    v_dot2_f32_bf16 v22, v187, v11, v22
    s_waitcnt vmcnt(32)
    v_dot2_f32_bf16 v23, v188, v8, 0
    v_dot2_f32_bf16 v23, v189, v9, v23
    v_dot2_f32_bf16 v23, v190, v10, v23
    v_dot2_f32_bf16 v23, v191, v11, v23
    v_permlane16_swap_b32 v16, v20
    v_permlane16_swap_b32 v17, v21
    v_permlane16_swap_b32 v18, v22
    v_permlane16_swap_b32 v19, v23
    v_add_f32 v16, v16, v20
    v_add_f32 v17, v17, v21
    v_add_f32 v18, v18, v22
    v_add_f32 v19, v19, v23
    v_add_f32_dpp v20, v16, v16 row_ror:8 row_mask:0xf bank_mask:0x3
    v_add_f32_dpp v20, v18, v18 row_ror:8 row_mask:0xf bank_mask:0xc
    v_add_f32_dpp v21, v17, v17 row_ror:8 row_mask:0xf bank_mask:0x3
    v_add_f32_dpp v21, v19, v19 row_ror:8 row_mask:0xf bank_mask:0xc
    v_add_f32_dpp v16, v20, v20 row_half_mirror row_mask:0xf bank_mask:0x5
    s_nop 0
    v_add_f32_dpp v16, v21, v21 row_half_mirror row_mask:0xf bank_mask:0xa
    s_nop 1
    v_add_f32_dpp v16, v16, v16 quad_perm:[1,0,3,2] row_mask:0xf bank_mask:0xf
    s_nop 1
    v_add_f32_dpp v16, v16, v16 quad_perm:[2,3,0,1] row_mask:0xf bank_mask:0xf
    ds_write_b32 v57, v16 offset:17472
    v_max_f32 v58, v58, v16
    s_waitcnt vmcnt(31)
    v_dot2_f32_bf16 v16, v192, v8, 0
    v_dot2_f32_bf16 v16, v193, v9, v16
    v_dot2_f32_bf16 v16, v194, v10, v16
    v_dot2_f32_bf16 v16, v195, v11, v16
    s_waitcnt vmcnt(30)
    v_dot2_f32_bf16 v17, v196, v8, 0
    v_dot2_f32_bf16 v17, v197, v9, v17
    v_dot2_f32_bf16 v17, v198, v10, v17
    v_dot2_f32_bf16 v17, v199, v11, v17
    s_waitcnt vmcnt(29)
    v_dot2_f32_bf16 v18, v200, v8, 0
    v_dot2_f32_bf16 v18, v201, v9, v18
    v_dot2_f32_bf16 v18, v202, v10, v18
    v_dot2_f32_bf16 v18, v203, v11, v18
    s_waitcnt vmcnt(28)
    v_dot2_f32_bf16 v19, v204, v8, 0
    v_dot2_f32_bf16 v19, v205, v9, v19
    v_dot2_f32_bf16 v19, v206, v10, v19
    v_dot2_f32_bf16 v19, v207, v11, v19
    s_waitcnt vmcnt(27)
    v_dot2_f32_bf16 v20, v208, v8, 0
    v_dot2_f32_bf16 v20, v209, v9, v20
    v_dot2_f32_bf16 v20, v210, v10, v20
    v_dot2_f32_bf16 v20, v211, v11, v20
    s_waitcnt vmcnt(26)
    v_dot2_f32_bf16 v21, v212, v8, 0
    v_dot2_f32_bf16 v21, v213, v9, v21
    v_dot2_f32_bf16 v21, v214, v10, v21
    v_dot2_f32_bf16 v21, v215, v11, v21
    s_waitcnt vmcnt(25)
    v_dot2_f32_bf16 v22, v216, v8, 0
    v_dot2_f32_bf16 v22, v217, v9, v22
    v_dot2_f32_bf16 v22, v218, v10, v22
    v_dot2_f32_bf16 v22, v219, v11, v22
    s_waitcnt vmcnt(24)
    v_dot2_f32_bf16 v23, v220, v8, 0
    v_dot2_f32_bf16 v23, v221, v9, v23
    v_dot2_f32_bf16 v23, v222, v10, v23
    v_dot2_f32_bf16 v23, v223, v11, v23
    v_permlane16_swap_b32 v16, v20
    v_permlane16_swap_b32 v17, v21
    v_permlane16_swap_b32 v18, v22
    v_permlane16_swap_b32 v19, v23
    v_add_f32 v16, v16, v20
    v_add_f32 v17, v17, v21
    v_add_f32 v18, v18, v22
    v_add_f32 v19, v19, v23
    v_add_f32_dpp v20, v16, v16 row_ror:8 row_mask:0xf bank_mask:0x3
    v_add_f32_dpp v20, v18, v18 row_ror:8 row_mask:0xf bank_mask:0xc
    v_add_f32_dpp v21, v17, v17 row_ror:8 row_mask:0xf bank_mask:0x3
    v_add_f32_dpp v21, v19, v19 row_ror:8 row_mask:0xf bank_mask:0xc
    v_add_f32_dpp v16, v20, v20 row_half_mirror row_mask:0xf bank_mask:0x5
    s_nop 0
    v_add_f32_dpp v16, v21, v21 row_half_mirror row_mask:0xf bank_mask:0xa
    s_nop 1
    v_add_f32_dpp v16, v16, v16 quad_perm:[1,0,3,2] row_mask:0xf bank_mask:0xf
    s_nop 1
    v_add_f32_dpp v16, v16, v16 quad_perm:[2,3,0,1] row_mask:0xf bank_mask:0xf
    ds_write_b32 v57, v16 offset:17504
    v_max_f32 v58, v58, v16
    s_waitcnt vmcnt(23)
    v_dot2_f32_bf16 v16, v224, v8, 0
    v_dot2_f32_bf16 v16, v225, v9, v16
    v_dot2_f32_bf16 v16, v226, v10, v16
    v_dot2_f32_bf16 v16, v227, v11, v16
    s_waitcnt vmcnt(22)
    v_dot2_f32_bf16 v17, v228, v8, 0
    v_dot2_f32_bf16 v17, v229, v9, v17
    v_dot2_f32_bf16 v17, v230, v10, v17
    v_dot2_f32_bf16 v17, v231, v11, v17
    s_waitcnt vmcnt(21)
    v_dot2_f32_bf16 v18, v232, v8, 0
    v_dot2_f32_bf16 v18, v233, v9, v18
    v_dot2_f32_bf16 v18, v234, v10, v18
    v_dot2_f32_bf16 v18, v235, v11, v18
    s_waitcnt vmcnt(20)
    v_dot2_f32_bf16 v19, v236, v8, 0
    v_dot2_f32_bf16 v19, v237, v9, v19
    v_dot2_f32_bf16 v19, v238, v10, v19
    v_dot2_f32_bf16 v19, v239, v11, v19
    s_waitcnt vmcnt(19)
    v_dot2_f32_bf16 v20, v240, v8, 0
    v_dot2_f32_bf16 v20, v241, v9, v20
    v_dot2_f32_bf16 v20, v242, v10, v20
    v_dot2_f32_bf16 v20, v243, v11, v20
    s_waitcnt vmcnt(18)
    v_dot2_f32_bf16 v21, v244, v8, 0
    v_dot2_f32_bf16 v21, v245, v9, v21
    v_dot2_f32_bf16 v21, v246, v10, v21
    v_dot2_f32_bf16 v21, v247, v11, v21
    s_waitcnt vmcnt(17)
    v_dot2_f32_bf16 v22, v248, v8, 0
    v_dot2_f32_bf16 v22, v249, v9, v22
    v_dot2_f32_bf16 v22, v250, v10, v22
    v_dot2_f32_bf16 v22, v251, v11, v22
    s_waitcnt vmcnt(16)
    v_dot2_f32_bf16 v23, v252, v8, 0
    v_dot2_f32_bf16 v23, v253, v9, v23
    v_dot2_f32_bf16 v23, v254, v10, v23
    v_dot2_f32_bf16 v23, v255, v11, v23
    v_permlane16_swap_b32 v16, v20
    v_permlane16_swap_b32 v17, v21
    v_permlane16_swap_b32 v18, v22
    v_permlane16_swap_b32 v19, v23
    v_add_f32 v16, v16, v20
    v_add_f32 v17, v17, v21
    v_add_f32 v18, v18, v22
    v_add_f32 v19, v19, v23
    v_add_f32_dpp v20, v16, v16 row_ror:8 row_mask:0xf bank_mask:0x3
    v_add_f32_dpp v20, v18, v18 row_ror:8 row_mask:0xf bank_mask:0xc
    v_add_f32_dpp v21, v17, v17 row_ror:8 row_mask:0xf bank_mask:0x3
    v_add_f32_dpp v21, v19, v19 row_ror:8 row_mask:0xf bank_mask:0xc
    v_add_f32_dpp v16, v20, v20 row_half_mirror row_mask:0xf bank_mask:0x5
    s_nop 0
    v_add_f32_dpp v16, v21, v21 row_half_mirror row_mask:0xf bank_mask:0xa
    s_nop 1
    v_add_f32_dpp v16, v16, v16 quad_perm:[1,0,3,2] row_mask:0xf bank_mask:0xf
    s_nop 1
    v_add_f32_dpp v16, v16, v16 quad_perm:[2,3,0,1] row_mask:0xf bank_mask:0xf
    ds_write_b32 v57, v16 offset:17536
    v_max_f32 v58, v58, v16
    s_waitcnt vmcnt(15)
    v_dot2_f32_bf16 v16, v64, v8, 0
    v_dot2_f32_bf16 v16, v65, v9, v16
    v_dot2_f32_bf16 v16, v66, v10, v16
    v_dot2_f32_bf16 v16, v67, v11, v16
    s_add_u32 s11, s11, s21
    buffer_load_dwordx4 v[64:67], v3, s[44:47], s11 offen offset:0 nt
    buffer_load_dwordx4 v[128:131], v60, s[64:67], s19 offen
    s_waitcnt vmcnt(16)
    v_dot2_f32_bf16 v17, v68, v8, 0
    v_dot2_f32_bf16 v17, v69, v9, v17
    v_dot2_f32_bf16 v17, v70, v10, v17
    v_dot2_f32_bf16 v17, v71, v11, v17
    buffer_load_dwordx4 v[68:71], v3, s[44:47], s11 offen offset:1024 nt
    s_waitcnt vmcnt(16)
    v_dot2_f32_bf16 v18, v72, v8, 0
    v_dot2_f32_bf16 v18, v73, v9, v18
    v_dot2_f32_bf16 v18, v74, v10, v18
    v_dot2_f32_bf16 v18, v75, v11, v18
    buffer_load_dwordx4 v[72:75], v3, s[44:47], s11 offen offset:2048 nt
    s_waitcnt vmcnt(16)
    v_dot2_f32_bf16 v19, v76, v8, 0
    v_dot2_f32_bf16 v19, v77, v9, v19
    v_dot2_f32_bf16 v19, v78, v10, v19
    v_dot2_f32_bf16 v19, v79, v11, v19
    buffer_load_dwordx4 v[76:79], v3, s[44:47], s11 offen offset:3072 nt
    buffer_load_dwordx4 v[160:163], v60, s[68:71], s19 offen
    s_add_u32 s19, s19, s20
    s_waitcnt vmcnt(17)
    v_dot2_f32_bf16 v20, v80, v8, 0
    v_dot2_f32_bf16 v20, v81, v9, v20
    v_dot2_f32_bf16 v20, v82, v10, v20
    v_dot2_f32_bf16 v20, v83, v11, v20
    s_add_u32 s12, s12, s21
    buffer_load_dwordx4 v[80:83], v3, s[44:47], s12 offen offset:0 nt
    s_waitcnt vmcnt(17)
    v_dot2_f32_bf16 v21, v84, v8, 0
    v_dot2_f32_bf16 v21, v85, v9, v21
    v_dot2_f32_bf16 v21, v86, v10, v21
    v_dot2_f32_bf16 v21, v87, v11, v21
    buffer_load_dwordx4 v[84:87], v3, s[44:47], s12 offen offset:1024 nt
    s_waitcnt vmcnt(17)
    v_dot2_f32_bf16 v22, v88, v8, 0
    v_dot2_f32_bf16 v22, v89, v9, v22
    v_dot2_f32_bf16 v22, v90, v10, v22
    v_dot2_f32_bf16 v22, v91, v11, v22
    buffer_load_dwordx4 v[88:91], v3, s[44:47], s12 offen offset:2048 nt
    s_waitcnt vmcnt(17)
    v_dot2_f32_bf16 v23, v92, v8, 0
    v_dot2_f32_bf16 v23, v93, v9, v23
    v_dot2_f32_bf16 v23, v94, v10, v23
    v_dot2_f32_bf16 v23, v95, v11, v23
    buffer_load_dwordx4 v[92:95], v3, s[44:47], s12 offen offset:3072 nt
    buffer_load_dwordx4 v[132:135], v60, s[64:67], s19 offen
    v_permlane16_swap_b32 v16, v20
    v_permlane16_swap_b32 v17, v21
    v_permlane16_swap_b32 v18, v22
    v_permlane16_swap_b32 v19, v23
    v_add_f32 v16, v16, v20
    v_add_f32 v17, v17, v21
    v_add_f32 v18, v18, v22
    v_add_f32 v19, v19, v23
    v_add_f32_dpp v20, v16, v16 row_ror:8 row_mask:0xf bank_mask:0x3
    v_add_f32_dpp v20, v18, v18 row_ror:8 row_mask:0xf bank_mask:0xc
    v_add_f32_dpp v21, v17, v17 row_ror:8 row_mask:0xf bank_mask:0x3
    v_add_f32_dpp v21, v19, v19 row_ror:8 row_mask:0xf bank_mask:0xc
    v_add_f32_dpp v16, v20, v20 row_half_mirror row_mask:0xf bank_mask:0x5
    s_nop 0
    v_add_f32_dpp v16, v21, v21 row_half_mirror row_mask:0xf bank_mask:0xa
    s_nop 1
    v_add_f32_dpp v16, v16, v16 quad_perm:[1,0,3,2] row_mask:0xf bank_mask:0xf
    s_nop 1
    v_add_f32_dpp v16, v16, v16 quad_perm:[2,3,0,1] row_mask:0xf bank_mask:0xf
    ds_write_b32 v57, v16 offset:17568
    v_max_f32 v58, v58, v16
    s_waitcnt vmcnt(18)
    v_dot2_f32_bf16 v16, v96, v8, 0
    v_dot2_f32_bf16 v16, v97, v9, v16
    v_dot2_f32_bf16 v16, v98, v10, v16
    v_dot2_f32_bf16 v16, v99, v11, v16
    s_add_u32 s9, s9, s21
    buffer_load_dwordx4 v[96:99], v3, s[44:47], s9 offen offset:0 nt
    s_waitcnt vmcnt(18)
    v_dot2_f32_bf16 v17, v100, v8, 0
    v_dot2_f32_bf16 v17, v101, v9, v17
    v_dot2_f32_bf16 v17, v102, v10, v17
    v_dot2_f32_bf16 v17, v103, v11, v17
    buffer_load_dwordx4 v[100:103], v3, s[44:47], s9 offen offset:1024 nt
    s_waitcnt vmcnt(18)
    v_dot2_f32_bf16 v18, v104, v8, 0
    v_dot2_f32_bf16 v18, v105, v9, v18
    v_dot2_f32_bf16 v18, v106, v10, v18
    v_dot2_f32_bf16 v18, v107, v11, v18
    buffer_load_dwordx4 v[104:107], v3, s[44:47], s9 offen offset:2048 nt
    s_waitcnt vmcnt(18)
    v_dot2_f32_bf16 v19, v108, v8, 0
    v_dot2_f32_bf16 v19, v109, v9, v19
    v_dot2_f32_bf16 v19, v110, v10, v19
    v_dot2_f32_bf16 v19, v111, v11, v19
    buffer_load_dwordx4 v[108:111], v3, s[44:47], s9 offen offset:3072 nt
    buffer_load_dwordx4 v[164:167], v60, s[68:71], s19 offen
    s_add_u32 s19, s19, s20
    s_waitcnt vmcnt(19)
    v_dot2_f32_bf16 v20, v112, v8, 0
    v_dot2_f32_bf16 v20, v113, v9, v20
    v_dot2_f32_bf16 v20, v114, v10, v20
    v_dot2_f32_bf16 v20, v115, v11, v20
    s_add_u32 s10, s10, s21
    buffer_load_dwordx4 v[112:115], v3, s[44:47], s10 offen offset:0 nt
    s_waitcnt vmcnt(19)
    v_dot2_f32_bf16 v21, v116, v8, 0
    v_dot2_f32_bf16 v21, v117, v9, v21
    v_dot2_f32_bf16 v21, v118, v10, v21
    v_dot2_f32_bf16 v21, v119, v11, v21
    buffer_load_dwordx4 v[116:119], v3, s[44:47], s10 offen offset:1024 nt
    s_waitcnt vmcnt(19)
    v_dot2_f32_bf16 v22, v120, v8, 0
    v_dot2_f32_bf16 v22, v121, v9, v22
    v_dot2_f32_bf16 v22, v122, v10, v22
    v_dot2_f32_bf16 v22, v123, v11, v22
    buffer_load_dwordx4 v[120:123], v3, s[44:47], s10 offen offset:2048 nt
    buffer_load_dwordx4 v[136:139], v60, s[64:67], s19 offen
    s_waitcnt vmcnt(20)
    v_dot2_f32_bf16 v23, v124, v8, 0
    v_dot2_f32_bf16 v23, v125, v9, v23
    v_dot2_f32_bf16 v23, v126, v10, v23
    v_dot2_f32_bf16 v23, v127, v11, v23
    buffer_load_dwordx4 v[124:127], v3, s[44:47], s10 offen offset:3072 nt
    v_permlane16_swap_b32 v16, v20
    v_permlane16_swap_b32 v17, v21
    v_permlane16_swap_b32 v18, v22
    v_permlane16_swap_b32 v19, v23
    v_add_f32 v16, v16, v20
    v_add_f32 v17, v17, v21
    v_add_f32 v18, v18, v22
    v_add_f32 v19, v19, v23
    v_add_f32_dpp v20, v16, v16 row_ror:8 row_mask:0xf bank_mask:0x3
    v_add_f32_dpp v20, v18, v18 row_ror:8 row_mask:0xf bank_mask:0xc
    v_add_f32_dpp v21, v17, v17 row_ror:8 row_mask:0xf bank_mask:0x3
    v_add_f32_dpp v21, v19, v19 row_ror:8 row_mask:0xf bank_mask:0xc
    v_add_f32_dpp v16, v20, v20 row_half_mirror row_mask:0xf bank_mask:0x5
    s_nop 0
    v_add_f32_dpp v16, v21, v21 row_half_mirror row_mask:0xf bank_mask:0xa
    s_nop 1
    v_add_f32_dpp v16, v16, v16 quad_perm:[1,0,3,2] row_mask:0xf bank_mask:0xf
    s_nop 1
    v_add_f32_dpp v16, v16, v16 quad_perm:[2,3,0,1] row_mask:0xf bank_mask:0xf
    ds_write_b32 v57, v16 offset:17600
    v_max_f32 v58, v58, v16
    s_waitcnt vmcnt(20)
    v_dot2_f32_bf16 v16, v64, v8, 0
    v_dot2_f32_bf16 v16, v65, v9, v16
    v_dot2_f32_bf16 v16, v66, v10, v16
    v_dot2_f32_bf16 v16, v67, v11, v16
    s_add_u32 s11, s11, s21
    buffer_load_dwordx4 v[64:67], v3, s[44:47], s11 offen offset:0 nt
    s_waitcnt vmcnt(19)
    v_dot2_f32_bf16 v17, v68, v8, 0
    v_dot2_f32_bf16 v17, v69, v9, v17
    v_dot2_f32_bf16 v17, v70, v10, v17
    v_dot2_f32_bf16 v17, v71, v11, v17
    buffer_load_dwordx4 v[68:71], v3, s[44:47], s11 offen offset:1024 nt
    s_waitcnt vmcnt(19)
    v_dot2_f32_bf16 v18, v72, v8, 0
    v_dot2_f32_bf16 v18, v73, v9, v18
    v_dot2_f32_bf16 v18, v74, v10, v18
    v_dot2_f32_bf16 v18, v75, v11, v18
    buffer_load_dwordx4 v[72:75], v3, s[44:47], s11 offen offset:2048 nt
    buffer_load_dwordx4 v[168:171], v60, s[68:71], s19 offen
    s_add_u32 s19, s19, s20
    s_waitcnt vmcnt(20)
    v_dot2_f32_bf16 v19, v76, v8, 0
    v_dot2_f32_bf16 v19, v77, v9, v19
    v_dot2_f32_bf16 v19, v78, v10, v19
    v_dot2_f32_bf16 v19, v79, v11, v19
    buffer_load_dwordx4 v[76:79], v3, s[44:47], s11 offen offset:3072 nt
    s_waitcnt vmcnt(19)
    v_dot2_f32_bf16 v20, v80, v8, 0
    v_dot2_f32_bf16 v20, v81, v9, v20
    v_dot2_f32_bf16 v20, v82, v10, v20
    v_dot2_f32_bf16 v20, v83, v11, v20
    s_add_u32 s12, s12, s21
    buffer_load_dwordx4 v[80:83], v3, s[44:47], s12 offen offset:0 nt
    s_waitcnt vmcnt(19)
    v_dot2_f32_bf16 v21, v84, v8, 0
    v_dot2_f32_bf16 v21, v85, v9, v21
    v_dot2_f32_bf16 v21, v86, v10, v21
    v_dot2_f32_bf16 v21, v87, v11, v21
    buffer_load_dwordx4 v[84:87], v3, s[44:47], s12 offen offset:1024 nt
    s_waitcnt vmcnt(19)
    v_dot2_f32_bf16 v22, v88, v8, 0
    v_dot2_f32_bf16 v22, v89, v9, v22
    v_dot2_f32_bf16 v22, v90, v10, v22
    v_dot2_f32_bf16 v22, v91, v11, v22
    buffer_load_dwordx4 v[88:91], v3, s[44:47], s12 offen offset:2048 nt
    buffer_load_dwordx4 v[140:143], v60, s[64:67], s19 offen
    s_waitcnt vmcnt(20)
    v_dot2_f32_bf16 v23, v92, v8, 0
    v_dot2_f32_bf16 v23, v93, v9, v23
    v_dot2_f32_bf16 v23, v94, v10, v23
    v_dot2_f32_bf16 v23, v95, v11, v23
    buffer_load_dwordx4 v[92:95], v3, s[44:47], s12 offen offset:3072 nt
    v_permlane16_swap_b32 v16, v20
    v_permlane16_swap_b32 v17, v21
    v_permlane16_swap_b32 v18, v22
    v_permlane16_swap_b32 v19, v23
    v_add_f32 v16, v16, v20
    v_add_f32 v17, v17, v21
    v_add_f32 v18, v18, v22
    v_add_f32 v19, v19, v23
    v_add_f32_dpp v20, v16, v16 row_ror:8 row_mask:0xf bank_mask:0x3
    v_add_f32_dpp v20, v18, v18 row_ror:8 row_mask:0xf bank_mask:0xc
    v_add_f32_dpp v21, v17, v17 row_ror:8 row_mask:0xf bank_mask:0x3
    v_add_f32_dpp v21, v19, v19 row_ror:8 row_mask:0xf bank_mask:0xc
    v_add_f32_dpp v16, v20, v20 row_half_mirror row_mask:0xf bank_mask:0x5
    s_nop 0
    v_add_f32_dpp v16, v21, v21 row_half_mirror row_mask:0xf bank_mask:0xa
    s_nop 1
    v_add_f32_dpp v16, v16, v16 quad_perm:[1,0,3,2] row_mask:0xf bank_mask:0xf
    s_nop 1
    v_add_f32_dpp v16, v16, v16 quad_perm:[2,3,0,1] row_mask:0xf bank_mask:0xf
    ds_write_b32 v57, v16 offset:17632
    v_max_f32 v58, v58, v16
    s_waitcnt vmcnt(19)
    v_dot2_f32_bf16 v16, v96, v8, 0
    v_dot2_f32_bf16 v16, v97, v9, v16
    v_dot2_f32_bf16 v16, v98, v10, v16
    v_dot2_f32_bf16 v16, v99, v11, v16
    s_add_u32 s9, s9, s21
    buffer_load_dwordx4 v[96:99], v3, s[44:47], s9 offen offset:0 nt
    s_waitcnt vmcnt(19)
    v_dot2_f32_bf16 v17, v100, v8, 0
    v_dot2_f32_bf16 v17, v101, v9, v17
    v_dot2_f32_bf16 v17, v102, v10, v17
    v_dot2_f32_bf16 v17, v103, v11, v17
    buffer_load_dwordx4 v[100:103], v3, s[44:47], s9 offen offset:1024 nt
    buffer_load_dwordx4 v[172:175], v60, s[68:71], s19 offen
    s_add_u32 s19, s19, s20
    s_waitcnt vmcnt(20)
    v_dot2_f32_bf16 v18, v104, v8, 0
    v_dot2_f32_bf16 v18, v105, v9, v18
    v_dot2_f32_bf16 v18, v106, v10, v18
    v_dot2_f32_bf16 v18, v107, v11, v18
    buffer_load_dwordx4 v[104:107], v3, s[44:47], s9 offen offset:2048 nt
    s_waitcnt vmcnt(20)
    v_dot2_f32_bf16 v19, v108, v8, 0
    v_dot2_f32_bf16 v19, v109, v9, v19
    v_dot2_f32_bf16 v19, v110, v10, v19
    v_dot2_f32_bf16 v19, v111, v11, v19
    buffer_load_dwordx4 v[108:111], v3, s[44:47], s9 offen offset:3072 nt
    s_waitcnt vmcnt(19)
    v_dot2_f32_bf16 v20, v112, v8, 0
    v_dot2_f32_bf16 v20, v113, v9, v20
    v_dot2_f32_bf16 v20, v114, v10, v20
    v_dot2_f32_bf16 v20, v115, v11, v20
    s_add_u32 s10, s10, s21
    buffer_load_dwordx4 v[112:115], v3, s[44:47], s10 offen offset:0 nt
    s_waitcnt vmcnt(19)
    v_dot2_f32_bf16 v21, v116, v8, 0
    v_dot2_f32_bf16 v21, v117, v9, v21
    v_dot2_f32_bf16 v21, v118, v10, v21
    v_dot2_f32_bf16 v21, v119, v11, v21
    buffer_load_dwordx4 v[116:119], v3, s[44:47], s10 offen offset:1024 nt
    buffer_load_dwordx4 v[144:147], v60, s[64:67], s19 offen
    s_waitcnt vmcnt(20)
    v_dot2_f32_bf16 v22, v120, v8, 0
    v_dot2_f32_bf16 v22, v121, v9, v22
    v_dot2_f32_bf16 v22, v122, v10, v22
    v_dot2_f32_bf16 v22, v123, v11, v22
    buffer_load_dwordx4 v[120:123], v3, s[44:47], s10 offen offset:2048 nt
    s_waitcnt vmcnt(19)
    v_dot2_f32_bf16 v23, v124, v8, 0
    v_dot2_f32_bf16 v23, v125, v9, v23
    v_dot2_f32_bf16 v23, v126, v10, v23
    v_dot2_f32_bf16 v23, v127, v11, v23
    buffer_load_dwordx4 v[124:127], v3, s[44:47], s10 offen offset:3072 nt
    v_permlane16_swap_b32 v16, v20
    v_permlane16_swap_b32 v17, v21
    v_permlane16_swap_b32 v18, v22
    v_permlane16_swap_b32 v19, v23
    v_add_f32 v16, v16, v20
    v_add_f32 v17, v17, v21
    v_add_f32 v18, v18, v22
    v_add_f32 v19, v19, v23
    v_add_f32_dpp v20, v16, v16 row_ror:8 row_mask:0xf bank_mask:0x3
    v_add_f32_dpp v20, v18, v18 row_ror:8 row_mask:0xf bank_mask:0xc
    v_add_f32_dpp v21, v17, v17 row_ror:8 row_mask:0xf bank_mask:0x3
    v_add_f32_dpp v21, v19, v19 row_ror:8 row_mask:0xf bank_mask:0xc
    v_add_f32_dpp v16, v20, v20 row_half_mirror row_mask:0xf bank_mask:0x5
    s_nop 0
    v_add_f32_dpp v16, v21, v21 row_half_mirror row_mask:0xf bank_mask:0xa
    s_nop 1
    v_add_f32_dpp v16, v16, v16 quad_perm:[1,0,3,2] row_mask:0xf bank_mask:0xf
    s_nop 1
    v_add_f32_dpp v16, v16, v16 quad_perm:[2,3,0,1] row_mask:0xf bank_mask:0xf
    ds_write_b32 v57, v16 offset:17664
    v_max_f32 v58, v58, v16
    s_waitcnt vmcnt(19)
    v_dot2_f32_bf16 v16, v64, v8, 0
    v_dot2_f32_bf16 v16, v65, v9, v16
    v_dot2_f32_bf16 v16, v66, v10, v16
    v_dot2_f32_bf16 v16, v67, v11, v16
    s_add_u32 s11, s11, s21
    buffer_load_dwordx4 v[64:67], v3, s[44:47], s11 offen offset:0 nt
    s_waitcnt vmcnt(19)
    v_dot2_f32_bf16 v17, v68, v8, 0
    v_dot2_f32_bf16 v17, v69, v9, v17
    v_dot2_f32_bf16 v17, v70, v10, v17
    v_dot2_f32_bf16 v17, v71, v11, v17
    buffer_load_dwordx4 v[68:71], v3, s[44:47], s11 offen offset:1024 nt
    buffer_load_dwordx4 v[176:179], v60, s[68:71], s19 offen
    s_add_u32 s19, s19, s20
    s_waitcnt vmcnt(20)
    v_dot2_f32_bf16 v18, v72, v8, 0
    v_dot2_f32_bf16 v18, v73, v9, v18
    v_dot2_f32_bf16 v18, v74, v10, v18
    v_dot2_f32_bf16 v18, v75, v11, v18
    buffer_load_dwordx4 v[72:75], v3, s[44:47], s11 offen offset:2048 nt
    s_waitcnt vmcnt(19)
    v_dot2_f32_bf16 v19, v76, v8, 0
    v_dot2_f32_bf16 v19, v77, v9, v19
    v_dot2_f32_bf16 v19, v78, v10, v19
    v_dot2_f32_bf16 v19, v79, v11, v19
    buffer_load_dwordx4 v[76:79], v3, s[44:47], s11 offen offset:3072 nt
    s_waitcnt vmcnt(19)
    v_dot2_f32_bf16 v20, v80, v8, 0
    v_dot2_f32_bf16 v20, v81, v9, v20
    v_dot2_f32_bf16 v20, v82, v10, v20
    v_dot2_f32_bf16 v20, v83, v11, v20
    s_add_u32 s12, s12, s21
    buffer_load_dwordx4 v[80:83], v3, s[44:47], s12 offen offset:0 nt
    buffer_load_dwordx4 v[148:151], v60, s[64:67], s19 offen
    s_waitcnt vmcnt(20)
    v_dot2_f32_bf16 v21, v84, v8, 0
    v_dot2_f32_bf16 v21, v85, v9, v21
    v_dot2_f32_bf16 v21, v86, v10, v21
    v_dot2_f32_bf16 v21, v87, v11, v21
    buffer_load_dwordx4 v[84:87], v3, s[44:47], s12 offen offset:1024 nt
    s_waitcnt vmcnt(20)
    v_dot2_f32_bf16 v22, v88, v8, 0
    v_dot2_f32_bf16 v22, v89, v9, v22
    v_dot2_f32_bf16 v22, v90, v10, v22
    v_dot2_f32_bf16 v22, v91, v11, v22
    buffer_load_dwordx4 v[88:91], v3, s[44:47], s12 offen offset:2048 nt
    s_waitcnt vmcnt(19)
    v_dot2_f32_bf16 v23, v92, v8, 0
    v_dot2_f32_bf16 v23, v93, v9, v23
    v_dot2_f32_bf16 v23, v94, v10, v23
    v_dot2_f32_bf16 v23, v95, v11, v23
    buffer_load_dwordx4 v[92:95], v3, s[44:47], s12 offen offset:3072 nt
    v_permlane16_swap_b32 v16, v20
    v_permlane16_swap_b32 v17, v21
    v_permlane16_swap_b32 v18, v22
    v_permlane16_swap_b32 v19, v23
    v_add_f32 v16, v16, v20
    v_add_f32 v17, v17, v21
    v_add_f32 v18, v18, v22
    v_add_f32 v19, v19, v23
    v_add_f32_dpp v20, v16, v16 row_ror:8 row_mask:0xf bank_mask:0x3
    v_add_f32_dpp v20, v18, v18 row_ror:8 row_mask:0xf bank_mask:0xc
    v_add_f32_dpp v21, v17, v17 row_ror:8 row_mask:0xf bank_mask:0x3
    v_add_f32_dpp v21, v19, v19 row_ror:8 row_mask:0xf bank_mask:0xc
    v_add_f32_dpp v16, v20, v20 row_half_mirror row_mask:0xf bank_mask:0x5
    s_nop 0
    v_add_f32_dpp v16, v21, v21 row_half_mirror row_mask:0xf bank_mask:0xa
    s_nop 1
    v_add_f32_dpp v16, v16, v16 quad_perm:[1,0,3,2] row_mask:0xf bank_mask:0xf
    s_nop 1
    v_add_f32_dpp v16, v16, v16 quad_perm:[2,3,0,1] row_mask:0xf bank_mask:0xf
    ds_write_b32 v57, v16 offset:17696
    v_max_f32 v58, v58, v16
    s_waitcnt vmcnt(19)
    v_dot2_f32_bf16 v16, v96, v8, 0
    v_dot2_f32_bf16 v16, v97, v9, v16
    v_dot2_f32_bf16 v16, v98, v10, v16
    v_dot2_f32_bf16 v16, v99, v11, v16
    s_add_u32 s9, s9, s21
    buffer_load_dwordx4 v[96:99], v3, s[44:47], s9 offen offset:0 nt
    buffer_load_dwordx4 v[180:183], v60, s[68:71], s19 offen
    s_add_u32 s19, s19, s20
    s_waitcnt vmcnt(20)
    v_dot2_f32_bf16 v17, v100, v8, 0
    v_dot2_f32_bf16 v17, v101, v9, v17
    v_dot2_f32_bf16 v17, v102, v10, v17
    v_dot2_f32_bf16 v17, v103, v11, v17
    buffer_load_dwordx4 v[100:103], v3, s[44:47], s9 offen offset:1024 nt
    s_waitcnt vmcnt(19)
    v_dot2_f32_bf16 v18, v104, v8, 0
    v_dot2_f32_bf16 v18, v105, v9, v18
    v_dot2_f32_bf16 v18, v106, v10, v18
    v_dot2_f32_bf16 v18, v107, v11, v18
    buffer_load_dwordx4 v[104:107], v3, s[44:47], s9 offen offset:2048 nt
    s_waitcnt vmcnt(19)
    v_dot2_f32_bf16 v19, v108, v8, 0
    v_dot2_f32_bf16 v19, v109, v9, v19
    v_dot2_f32_bf16 v19, v110, v10, v19
    v_dot2_f32_bf16 v19, v111, v11, v19
    buffer_load_dwordx4 v[108:111], v3, s[44:47], s9 offen offset:3072 nt
    s_waitcnt vmcnt(19)
    v_dot2_f32_bf16 v20, v112, v8, 0
    v_dot2_f32_bf16 v20, v113, v9, v20
    v_dot2_f32_bf16 v20, v114, v10, v20
    v_dot2_f32_bf16 v20, v115, v11, v20
    s_add_u32 s10, s10, s21
    buffer_load_dwordx4 v[112:115], v3, s[44:47], s10 offen offset:0 nt
    buffer_load_dwordx4 v[152:155], v60, s[64:67], s19 offen
    s_waitcnt vmcnt(20)
    v_dot2_f32_bf16 v21, v116, v8, 0
    v_dot2_f32_bf16 v21, v117, v9, v21
    v_dot2_f32_bf16 v21, v118, v10, v21
    v_dot2_f32_bf16 v21, v119, v11, v21
    buffer_load_dwordx4 v[116:119], v3, s[44:47], s10 offen offset:1024 nt
    s_waitcnt vmcnt(19)
    v_dot2_f32_bf16 v22, v120, v8, 0
    v_dot2_f32_bf16 v22, v121, v9, v22
    v_dot2_f32_bf16 v22, v122, v10, v22
    v_dot2_f32_bf16 v22, v123, v11, v22
    buffer_load_dwordx4 v[120:123], v3, s[44:47], s10 offen offset:2048 nt
    s_waitcnt vmcnt(19)
    v_dot2_f32_bf16 v23, v124, v8, 0
    v_dot2_f32_bf16 v23, v125, v9, v23
    v_dot2_f32_bf16 v23, v126, v10, v23
    v_dot2_f32_bf16 v23, v127, v11, v23
    buffer_load_dwordx4 v[124:127], v3, s[44:47], s10 offen offset:3072 nt
    buffer_load_dwordx4 v[184:187], v60, s[68:71], s19 offen
    s_add_u32 s19, s19, s20
    v_permlane16_swap_b32 v16, v20
    v_permlane16_swap_b32 v17, v21
    v_permlane16_swap_b32 v18, v22
    v_permlane16_swap_b32 v19, v23
    v_add_f32 v16, v16, v20
    v_add_f32 v17, v17, v21
    v_add_f32 v18, v18, v22
    v_add_f32 v19, v19, v23
    v_add_f32_dpp v20, v16, v16 row_ror:8 row_mask:0xf bank_mask:0x3
    v_add_f32_dpp v20, v18, v18 row_ror:8 row_mask:0xf bank_mask:0xc
    v_add_f32_dpp v21, v17, v17 row_ror:8 row_mask:0xf bank_mask:0x3
    v_add_f32_dpp v21, v19, v19 row_ror:8 row_mask:0xf bank_mask:0xc
    v_add_f32_dpp v16, v20, v20 row_half_mirror row_mask:0xf bank_mask:0x5
    s_nop 0
    v_add_f32_dpp v16, v21, v21 row_half_mirror row_mask:0xf bank_mask:0xa
    s_nop 1
    v_add_f32_dpp v16, v16, v16 quad_perm:[1,0,3,2] row_mask:0xf bank_mask:0xf
    s_nop 1
    v_add_f32_dpp v16, v16, v16 quad_perm:[2,3,0,1] row_mask:0xf bank_mask:0xf
    ds_write_b32 v57, v16 offset:17728
    v_max_f32 v58, v58, v16
    s_waitcnt vmcnt(20)
    v_dot2_f32_bf16 v16, v64, v8, 0
    v_dot2_f32_bf16 v16, v65, v9, v16
    v_dot2_f32_bf16 v16, v66, v10, v16
    v_dot2_f32_bf16 v16, v67, v11, v16
    s_add_u32 s11, s11, s21
    buffer_load_dwordx4 v[64:67], v3, s[44:47], s11 offen offset:0 nt
    s_waitcnt vmcnt(20)
    v_dot2_f32_bf16 v17, v68, v8, 0
    v_dot2_f32_bf16 v17, v69, v9, v17
    v_dot2_f32_bf16 v17, v70, v10, v17
    v_dot2_f32_bf16 v17, v71, v11, v17
    buffer_load_dwordx4 v[68:71], v3, s[44:47], s11 offen offset:1024 nt
    s_waitcnt vmcnt(19)
    v_dot2_f32_bf16 v18, v72, v8, 0
    v_dot2_f32_bf16 v18, v73, v9, v18
    v_dot2_f32_bf16 v18, v74, v10, v18
    v_dot2_f32_bf16 v18, v75, v11, v18
    buffer_load_dwordx4 v[72:75], v3, s[44:47], s11 offen offset:2048 nt
    s_waitcnt vmcnt(19)
    v_dot2_f32_bf16 v19, v76, v8, 0
    v_dot2_f32_bf16 v19, v77, v9, v19
    v_dot2_f32_bf16 v19, v78, v10, v19
    v_dot2_f32_bf16 v19, v79, v11, v19
    buffer_load_dwordx4 v[76:79], v3, s[44:47], s11 offen offset:3072 nt
    buffer_load_dwordx4 v[156:159], v60, s[64:67], s19 offen
    s_waitcnt vmcnt(20)
    v_dot2_f32_bf16 v20, v80, v8, 0
    v_dot2_f32_bf16 v20, v81, v9, v20
    v_dot2_f32_bf16 v20, v82, v10, v20
    v_dot2_f32_bf16 v20, v83, v11, v20
    s_add_u32 s12, s12, s21
    buffer_load_dwordx4 v[80:83], v3, s[44:47], s12 offen offset:0 nt
    s_waitcnt vmcnt(19)
    v_dot2_f32_bf16 v21, v84, v8, 0
    v_dot2_f32_bf16 v21, v85, v9, v21
    v_dot2_f32_bf16 v21, v86, v10, v21
    v_dot2_f32_bf16 v21, v87, v11, v21
    buffer_load_dwordx4 v[84:87], v3, s[44:47], s12 offen offset:1024 nt
    s_waitcnt vmcnt(19)
    v_dot2_f32_bf16 v22, v88, v8, 0
    v_dot2_f32_bf16 v22, v89, v9, v22
    v_dot2_f32_bf16 v22, v90, v10, v22
    v_dot2_f32_bf16 v22, v91, v11, v22
    buffer_load_dwordx4 v[88:91], v3, s[44:47], s12 offen offset:2048 nt
    s_waitcnt vmcnt(19)
    v_dot2_f32_bf16 v23, v92, v8, 0
    v_dot2_f32_bf16 v23, v93, v9, v23
    v_dot2_f32_bf16 v23, v94, v10, v23
    v_dot2_f32_bf16 v23, v95, v11, v23
    buffer_load_dwordx4 v[92:95], v3, s[44:47], s12 offen offset:3072 nt
    buffer_load_dwordx4 v[188:191], v60, s[68:71], s19 offen
    s_add_u32 s19, s19, s20
    v_permlane16_swap_b32 v16, v20
    v_permlane16_swap_b32 v17, v21
    v_permlane16_swap_b32 v18, v22
    v_permlane16_swap_b32 v19, v23
    v_add_f32 v16, v16, v20
    v_add_f32 v17, v17, v21
    v_add_f32 v18, v18, v22
    v_add_f32 v19, v19, v23
    v_add_f32_dpp v20, v16, v16 row_ror:8 row_mask:0xf bank_mask:0x3
    v_add_f32_dpp v20, v18, v18 row_ror:8 row_mask:0xf bank_mask:0xc
    v_add_f32_dpp v21, v17, v17 row_ror:8 row_mask:0xf bank_mask:0x3
    v_add_f32_dpp v21, v19, v19 row_ror:8 row_mask:0xf bank_mask:0xc
    v_add_f32_dpp v16, v20, v20 row_half_mirror row_mask:0xf bank_mask:0x5
    s_nop 0
    v_add_f32_dpp v16, v21, v21 row_half_mirror row_mask:0xf bank_mask:0xa
    s_nop 1
    v_add_f32_dpp v16, v16, v16 quad_perm:[1,0,3,2] row_mask:0xf bank_mask:0xf
    s_nop 1
    v_add_f32_dpp v16, v16, v16 quad_perm:[2,3,0,1] row_mask:0xf bank_mask:0xf
    ds_write_b32 v57, v16 offset:17760
    v_max_f32 v58, v58, v16
    s_waitcnt vmcnt(20)
    v_dot2_f32_bf16 v16, v96, v8, 0
    v_dot2_f32_bf16 v16, v97, v9, v16
    v_dot2_f32_bf16 v16, v98, v10, v16
    v_dot2_f32_bf16 v16, v99, v11, v16
    s_add_u32 s9, s9, s21
    buffer_load_dwordx4 v[96:99], v3, s[44:47], s9 offen offset:0 nt
    s_waitcnt vmcnt(19)
    v_dot2_f32_bf16 v17, v100, v8, 0
    v_dot2_f32_bf16 v17, v101, v9, v17
    v_dot2_f32_bf16 v17, v102, v10, v17
    v_dot2_f32_bf16 v17, v103, v11, v17
    buffer_load_dwordx4 v[100:103], v3, s[44:47], s9 offen offset:1024 nt
    s_waitcnt vmcnt(19)
    v_dot2_f32_bf16 v18, v104, v8, 0
    v_dot2_f32_bf16 v18, v105, v9, v18
    v_dot2_f32_bf16 v18, v106, v10, v18
    v_dot2_f32_bf16 v18, v107, v11, v18
    buffer_load_dwordx4 v[104:107], v3, s[44:47], s9 offen offset:2048 nt
    buffer_load_dwordx4 v[192:195], v53, s[72:75], 0 offen offset:0
    s_waitcnt vmcnt(20)
    v_dot2_f32_bf16 v19, v108, v8, 0
    v_dot2_f32_bf16 v19, v109, v9, v19
    v_dot2_f32_bf16 v19, v110, v10, v19
    v_dot2_f32_bf16 v19, v111, v11, v19
    buffer_load_dwordx4 v[108:111], v3, s[44:47], s9 offen offset:3072 nt
    s_waitcnt vmcnt(20)
    v_dot2_f32_bf16 v20, v112, v8, 0
    v_dot2_f32_bf16 v20, v113, v9, v20
    v_dot2_f32_bf16 v20, v114, v10, v20
    v_dot2_f32_bf16 v20, v115, v11, v20
    s_add_u32 s10, s10, s21
    buffer_load_dwordx4 v[112:115], v3, s[44:47], s10 offen offset:0 nt
    s_waitcnt vmcnt(19)
    v_dot2_f32_bf16 v21, v116, v8, 0
    v_dot2_f32_bf16 v21, v117, v9, v21
    v_dot2_f32_bf16 v21, v118, v10, v21
    v_dot2_f32_bf16 v21, v119, v11, v21
    buffer_load_dwordx4 v[116:119], v3, s[44:47], s10 offen offset:1024 nt
    s_waitcnt vmcnt(19)
    v_dot2_f32_bf16 v22, v120, v8, 0
    v_dot2_f32_bf16 v22, v121, v9, v22
    v_dot2_f32_bf16 v22, v122, v10, v22
    v_dot2_f32_bf16 v22, v123, v11, v22
    buffer_load_dwordx4 v[120:123], v3, s[44:47], s10 offen offset:2048 nt
    buffer_load_dwordx4 v[196:199], v53, s[72:75], 0 offen offset:896
    s_waitcnt vmcnt(20)
    v_dot2_f32_bf16 v23, v124, v8, 0
    v_dot2_f32_bf16 v23, v125, v9, v23
    v_dot2_f32_bf16 v23, v126, v10, v23
    v_dot2_f32_bf16 v23, v127, v11, v23
    buffer_load_dwordx4 v[124:127], v3, s[44:47], s10 offen offset:3072 nt
    v_permlane16_swap_b32 v16, v20
    v_permlane16_swap_b32 v17, v21
    v_permlane16_swap_b32 v18, v22
    v_permlane16_swap_b32 v19, v23
    v_add_f32 v16, v16, v20
    v_add_f32 v17, v17, v21
    v_add_f32 v18, v18, v22
    v_add_f32 v19, v19, v23
    v_add_f32_dpp v20, v16, v16 row_ror:8 row_mask:0xf bank_mask:0x3
    v_add_f32_dpp v20, v18, v18 row_ror:8 row_mask:0xf bank_mask:0xc
    v_add_f32_dpp v21, v17, v17 row_ror:8 row_mask:0xf bank_mask:0x3
    v_add_f32_dpp v21, v19, v19 row_ror:8 row_mask:0xf bank_mask:0xc
    v_add_f32_dpp v16, v20, v20 row_half_mirror row_mask:0xf bank_mask:0x5
    s_nop 0
    v_add_f32_dpp v16, v21, v21 row_half_mirror row_mask:0xf bank_mask:0xa
    s_nop 1
    v_add_f32_dpp v16, v16, v16 quad_perm:[1,0,3,2] row_mask:0xf bank_mask:0xf
    s_nop 1
    v_add_f32_dpp v16, v16, v16 quad_perm:[2,3,0,1] row_mask:0xf bank_mask:0xf
    ds_write_b32 v57, v16 offset:17792
    v_max_f32 v58, v58, v16
    s_waitcnt vmcnt(19)
    v_dot2_f32_bf16 v16, v64, v8, 0
    v_dot2_f32_bf16 v16, v65, v9, v16
    v_dot2_f32_bf16 v16, v66, v10, v16
    v_dot2_f32_bf16 v16, v67, v11, v16
    s_add_u32 s11, s11, s21
    buffer_load_dwordx4 v[64:67], v3, s[44:47], s11 offen offset:0 nt
    s_waitcnt vmcnt(19)
    v_dot2_f32_bf16 v17, v68, v8, 0
    v_dot2_f32_bf16 v17, v69, v9, v17
    v_dot2_f32_bf16 v17, v70, v10, v17
    v_dot2_f32_bf16 v17, v71, v11, v17
    buffer_load_dwordx4 v[68:71], v3, s[44:47], s11 offen offset:1024 nt
    s_waitcnt vmcnt(19)
    v_dot2_f32_bf16 v18, v72, v8, 0
    v_dot2_f32_bf16 v18, v73, v9, v18
    v_dot2_f32_bf16 v18, v74, v10, v18
    v_dot2_f32_bf16 v18, v75, v11, v18
    buffer_load_dwordx4 v[72:75], v3, s[44:47], s11 offen offset:2048 nt
    buffer_load_dwordx4 v[200:203], v53, s[72:75], 0 offen offset:1792
    s_waitcnt vmcnt(20)
    v_dot2_f32_bf16 v19, v76, v8, 0
    v_dot2_f32_bf16 v19, v77, v9, v19
    v_dot2_f32_bf16 v19, v78, v10, v19
    v_dot2_f32_bf16 v19, v79, v11, v19
    buffer_load_dwordx4 v[76:79], v3, s[44:47], s11 offen offset:3072 nt
    s_waitcnt vmcnt(19)
    v_dot2_f32_bf16 v20, v80, v8, 0
    v_dot2_f32_bf16 v20, v81, v9, v20
    v_dot2_f32_bf16 v20, v82, v10, v20
    v_dot2_f32_bf16 v20, v83, v11, v20
    s_add_u32 s12, s12, s21
    buffer_load_dwordx4 v[80:83], v3, s[44:47], s12 offen offset:0 nt
    s_waitcnt vmcnt(19)
    v_dot2_f32_bf16 v21, v84, v8, 0
    v_dot2_f32_bf16 v21, v85, v9, v21
    v_dot2_f32_bf16 v21, v86, v10, v21
    v_dot2_f32_bf16 v21, v87, v11, v21
    buffer_load_dwordx4 v[84:87], v3, s[44:47], s12 offen offset:1024 nt
    buffer_load_dwordx4 v[204:207], v53, s[72:75], 0 offen offset:2688
    s_waitcnt vmcnt(20)
    v_dot2_f32_bf16 v22, v88, v8, 0
    v_dot2_f32_bf16 v22, v89, v9, v22
    v_dot2_f32_bf16 v22, v90, v10, v22
    v_dot2_f32_bf16 v22, v91, v11, v22
    buffer_load_dwordx4 v[88:91], v3, s[44:47], s12 offen offset:2048 nt
    s_waitcnt vmcnt(20)
    v_dot2_f32_bf16 v23, v92, v8, 0
    v_dot2_f32_bf16 v23, v93, v9, v23
    v_dot2_f32_bf16 v23, v94, v10, v23
    v_dot2_f32_bf16 v23, v95, v11, v23
    buffer_load_dwordx4 v[92:95], v3, s[44:47], s12 offen offset:3072 nt
    v_permlane16_swap_b32 v16, v20
    v_permlane16_swap_b32 v17, v21
    v_permlane16_swap_b32 v18, v22
    v_permlane16_swap_b32 v19, v23
    v_add_f32 v16, v16, v20
    v_add_f32 v17, v17, v21
    v_add_f32 v18, v18, v22
    v_add_f32 v19, v19, v23
    v_add_f32_dpp v20, v16, v16 row_ror:8 row_mask:0xf bank_mask:0x3
    v_add_f32_dpp v20, v18, v18 row_ror:8 row_mask:0xf bank_mask:0xc
    v_add_f32_dpp v21, v17, v17 row_ror:8 row_mask:0xf bank_mask:0x3
    v_add_f32_dpp v21, v19, v19 row_ror:8 row_mask:0xf bank_mask:0xc
    v_add_f32_dpp v16, v20, v20 row_half_mirror row_mask:0xf bank_mask:0x5
    s_nop 0
    v_add_f32_dpp v16, v21, v21 row_half_mirror row_mask:0xf bank_mask:0xa
    s_nop 1
    v_add_f32_dpp v16, v16, v16 quad_perm:[1,0,3,2] row_mask:0xf bank_mask:0xf
    s_nop 1
    v_add_f32_dpp v16, v16, v16 quad_perm:[2,3,0,1] row_mask:0xf bank_mask:0xf
    ds_write_b32 v57, v16 offset:17824
    v_max_f32 v58, v58, v16
    s_waitcnt vmcnt(19)
    v_dot2_f32_bf16 v16, v96, v8, 0
    v_dot2_f32_bf16 v16, v97, v9, v16
    v_dot2_f32_bf16 v16, v98, v10, v16
    v_dot2_f32_bf16 v16, v99, v11, v16
    s_mov_b32 s9, 0
    buffer_load_dwordx4 v[96:99], v3, s[48:51], s9 offen offset:0 nt
    s_waitcnt vmcnt(19)
    v_dot2_f32_bf16 v17, v100, v8, 0
    v_dot2_f32_bf16 v17, v101, v9, v17
    v_dot2_f32_bf16 v17, v102, v10, v17
    v_dot2_f32_bf16 v17, v103, v11, v17
    buffer_load_dwordx4 v[100:103], v3, s[48:51], s9 offen offset:1024 nt
    buffer_load_dwordx4 v[208:211], v53, s[72:75], s20 offen offset:0
    s_waitcnt vmcnt(20)
    v_dot2_f32_bf16 v18, v104, v8, 0
    v_dot2_f32_bf16 v18, v105, v9, v18
    v_dot2_f32_bf16 v18, v106, v10, v18
    v_dot2_f32_bf16 v18, v107, v11, v18
    buffer_load_dwordx4 v[104:107], v3, s[48:51], s9 offen offset:2048 nt
    s_waitcnt vmcnt(19)
    v_dot2_f32_bf16 v19, v108, v8, 0
    v_dot2_f32_bf16 v19, v109, v9, v19
    v_dot2_f32_bf16 v19, v110, v10, v19
    v_dot2_f32_bf16 v19, v111, v11, v19
    buffer_load_dwordx4 v[108:111], v3, s[48:51], s9 offen offset:3072 nt
    s_waitcnt vmcnt(19)
    v_dot2_f32_bf16 v20, v112, v8, 0
    v_dot2_f32_bf16 v20, v113, v9, v20
    v_dot2_f32_bf16 v20, v114, v10, v20
    v_dot2_f32_bf16 v20, v115, v11, v20
    s_mov_b32 s10, 16384
    buffer_load_dwordx4 v[112:115], v3, s[48:51], s10 offen offset:0 nt
    s_waitcnt vmcnt(19)
    v_dot2_f32_bf16 v21, v116, v8, 0
    v_dot2_f32_bf16 v21, v117, v9, v21
    v_dot2_f32_bf16 v21, v118, v10, v21
    v_dot2_f32_bf16 v21, v119, v11, v21
    buffer_load_dwordx4 v[116:119], v3, s[48:51], s10 offen offset:1024 nt
    buffer_load_dwordx4 v[212:215], v53, s[72:75], s20 offen offset:896
    s_waitcnt vmcnt(20)
    v_dot2_f32_bf16 v22, v120, v8, 0
    v_dot2_f32_bf16 v22, v121, v9, v22
    v_dot2_f32_bf16 v22, v122, v10, v22
    v_dot2_f32_bf16 v22, v123, v11, v22
    buffer_load_dwordx4 v[120:123], v3, s[48:51], s10 offen offset:2048 nt
    s_waitcnt vmcnt(19)
    v_dot2_f32_bf16 v23, v124, v8, 0
    v_dot2_f32_bf16 v23, v125, v9, v23
    v_dot2_f32_bf16 v23, v126, v10, v23
    v_dot2_f32_bf16 v23, v127, v11, v23
    buffer_load_dwordx4 v[124:127], v3, s[48:51], s10 offen offset:3072 nt
    v_permlane16_swap_b32 v16, v20
    v_permlane16_swap_b32 v17, v21
    v_permlane16_swap_b32 v18, v22
    v_permlane16_swap_b32 v19, v23
    v_add_f32 v16, v16, v20
    v_add_f32 v17, v17, v21
    v_add_f32 v18, v18, v22
    v_add_f32 v19, v19, v23
    v_add_f32_dpp v20, v16, v16 row_ror:8 row_mask:0xf bank_mask:0x3
    v_add_f32_dpp v20, v18, v18 row_ror:8 row_mask:0xf bank_mask:0xc
    v_add_f32_dpp v21, v17, v17 row_ror:8 row_mask:0xf bank_mask:0x3
    v_add_f32_dpp v21, v19, v19 row_ror:8 row_mask:0xf bank_mask:0xc
    v_add_f32_dpp v16, v20, v20 row_half_mirror row_mask:0xf bank_mask:0x5
    s_nop 0
    v_add_f32_dpp v16, v21, v21 row_half_mirror row_mask:0xf bank_mask:0xa
    s_nop 1
    v_add_f32_dpp v16, v16, v16 quad_perm:[1,0,3,2] row_mask:0xf bank_mask:0xf
    s_nop 1
    v_add_f32_dpp v16, v16, v16 quad_perm:[2,3,0,1] row_mask:0xf bank_mask:0xf
    ds_write_b32 v57, v16 offset:17856
    v_max_f32 v58, v58, v16
    s_waitcnt vmcnt(19)
    v_dot2_f32_bf16 v16, v64, v8, 0
    v_dot2_f32_bf16 v16, v65, v9, v16
    v_dot2_f32_bf16 v16, v66, v10, v16
    v_dot2_f32_bf16 v16, v67, v11, v16
    s_mov_b32 s11, 32768
    buffer_load_dwordx4 v[64:67], v3, s[48:51], s11 offen offset:0 nt
    buffer_load_dwordx4 v[216:219], v53, s[72:75], s20 offen offset:1792
    s_waitcnt vmcnt(20)
    v_dot2_f32_bf16 v17, v68, v8, 0
    v_dot2_f32_bf16 v17, v69, v9, v17
    v_dot2_f32_bf16 v17, v70, v10, v17
    v_dot2_f32_bf16 v17, v71, v11, v17
    buffer_load_dwordx4 v[68:71], v3, s[48:51], s11 offen offset:1024 nt
    s_waitcnt vmcnt(20)
    v_dot2_f32_bf16 v18, v72, v8, 0
    v_dot2_f32_bf16 v18, v73, v9, v18
    v_dot2_f32_bf16 v18, v74, v10, v18
    v_dot2_f32_bf16 v18, v75, v11, v18
    buffer_load_dwordx4 v[72:75], v3, s[48:51], s11 offen offset:2048 nt
    s_waitcnt vmcnt(19)
    v_dot2_f32_bf16 v19, v76, v8, 0
    v_dot2_f32_bf16 v19, v77, v9, v19
    v_dot2_f32_bf16 v19, v78, v10, v19
    v_dot2_f32_bf16 v19, v79, v11, v19
    buffer_load_dwordx4 v[76:79], v3, s[48:51], s11 offen offset:3072 nt
    s_waitcnt vmcnt(19)
    v_dot2_f32_bf16 v20, v80, v8, 0
    v_dot2_f32_bf16 v20, v81, v9, v20
    v_dot2_f32_bf16 v20, v82, v10, v20
    v_dot2_f32_bf16 v20, v83, v11, v20
    s_mov_b32 s12, 49152
    buffer_load_dwordx4 v[80:83], v3, s[48:51], s12 offen offset:0 nt
    buffer_load_dwordx4 v[220:223], v53, s[72:75], s20 offen offset:2688
    s_waitcnt vmcnt(20)
    v_dot2_f32_bf16 v21, v84, v8, 0
    v_dot2_f32_bf16 v21, v85, v9, v21
    v_dot2_f32_bf16 v21, v86, v10, v21
    v_dot2_f32_bf16 v21, v87, v11, v21
    buffer_load_dwordx4 v[84:87], v3, s[48:51], s12 offen offset:1024 nt
    s_waitcnt vmcnt(19)
    v_dot2_f32_bf16 v22, v88, v8, 0
    v_dot2_f32_bf16 v22, v89, v9, v22
    v_dot2_f32_bf16 v22, v90, v10, v22
    v_dot2_f32_bf16 v22, v91, v11, v22
    buffer_load_dwordx4 v[88:91], v3, s[48:51], s12 offen offset:2048 nt
    s_waitcnt vmcnt(19)
    v_dot2_f32_bf16 v23, v92, v8, 0
    v_dot2_f32_bf16 v23, v93, v9, v23
    v_dot2_f32_bf16 v23, v94, v10, v23
    v_dot2_f32_bf16 v23, v95, v11, v23
    buffer_load_dwordx4 v[92:95], v3, s[48:51], s12 offen offset:3072 nt
    v_permlane16_swap_b32 v16, v20
    v_permlane16_swap_b32 v17, v21
    v_permlane16_swap_b32 v18, v22
    v_permlane16_swap_b32 v19, v23
    v_add_f32 v16, v16, v20
    v_add_f32 v17, v17, v21
    v_add_f32 v18, v18, v22
    v_add_f32 v19, v19, v23
    v_add_f32_dpp v20, v16, v16 row_ror:8 row_mask:0xf bank_mask:0x3
    v_add_f32_dpp v20, v18, v18 row_ror:8 row_mask:0xf bank_mask:0xc
    v_add_f32_dpp v21, v17, v17 row_ror:8 row_mask:0xf bank_mask:0x3
    v_add_f32_dpp v21, v19, v19 row_ror:8 row_mask:0xf bank_mask:0xc
    v_add_f32_dpp v16, v20, v20 row_half_mirror row_mask:0xf bank_mask:0x5
    s_nop 0
    v_add_f32_dpp v16, v21, v21 row_half_mirror row_mask:0xf bank_mask:0xa
    s_nop 1
    v_add_f32_dpp v16, v16, v16 quad_perm:[1,0,3,2] row_mask:0xf bank_mask:0xf
    s_nop 1
    v_add_f32_dpp v16, v16, v16 quad_perm:[2,3,0,1] row_mask:0xf bank_mask:0xf
    ds_write_b32 v57, v16 offset:17888
    v_max_f32 v58, v58, v16
    s_nop 1
    v_max_f32_dpp v58, v58, v58 quad_perm:[1,0,3,2] row_mask:0xf bank_mask:0xf
    s_nop 1
    v_max_f32_dpp v58, v58, v58 quad_perm:[2,3,0,1] row_mask:0xf bank_mask:0xf
    s_nop 1
    v_max_f32_dpp v58, v58, v58 row_half_mirror row_mask:0xf bank_mask:0xf
    s_nop 1
    v_max_f32_dpp v58, v58, v58 row_mirror row_mask:0xf bank_mask:0xf
    v_mov_b32 v59, v58
    s_nop 1
    v_permlane16_swap_b32 v58, v59
    v_max_f32 v58, v58, v59
    v_mov_b32 v59, v58
    s_nop 1
    v_permlane32_swap_b32 v58, v59
    v_max_f32 v58, v58, v59
    s_lshl_b32 s15, s7, 2
    v_mov_b32 v59, s15
    ds_write_b32 v59, v58 offset:29696
    s_waitcnt vmcnt(3)
    v_perm_b32 v16, v132, v128, s16
    v_perm_b32 v17, v132, v128, s17
    v_perm_b32 v18, v133, v129, s16
    v_perm_b32 v19, v133, v129, s17
    v_perm_b32 v20, v134, v130, s16
    v_perm_b32 v21, v134, v130, s17
    v_perm_b32 v22, v135, v131, s16
    v_perm_b32 v23, v135, v131, s17
    v_dot2_f32_bf16 v8, v16, v48, 0
    v_dot2_f32_bf16 v9, v17, v48, 0
    v_dot2_f32_bf16 v10, v18, v48, 0
    v_dot2_f32_bf16 v11, v19, v48, 0
    v_dot2_f32_bf16 v12, v20, v48, 0
    v_dot2_f32_bf16 v13, v21, v48, 0
    v_dot2_f32_bf16 v14, v22, v48, 0
    v_dot2_f32_bf16 v15, v23, v48, 0
    v_perm_b32 v16, v140, v136, s16
    v_perm_b32 v17, v140, v136, s17
    v_perm_b32 v18, v141, v137, s16
    v_perm_b32 v19, v141, v137, s17
    v_perm_b32 v20, v142, v138, s16
    v_perm_b32 v21, v142, v138, s17
    v_perm_b32 v22, v143, v139, s16
    v_perm_b32 v23, v143, v139, s17
    v_dot2_f32_bf16 v8, v16, v49, v8
    v_dot2_f32_bf16 v9, v17, v49, v9
    v_dot2_f32_bf16 v10, v18, v49, v10
    v_dot2_f32_bf16 v11, v19, v49, v11
    v_dot2_f32_bf16 v12, v20, v49, v12
    v_dot2_f32_bf16 v13, v21, v49, v13
    v_dot2_f32_bf16 v14, v22, v49, v14
    v_dot2_f32_bf16 v15, v23, v49, v15
    v_perm_b32 v16, v148, v144, s16
    v_perm_b32 v17, v148, v144, s17
    v_perm_b32 v18, v149, v145, s16
    v_perm_b32 v19, v149, v145, s17
    v_perm_b32 v20, v150, v146, s16
    v_perm_b32 v21, v150, v146, s17
    v_perm_b32 v22, v151, v147, s16
    v_perm_b32 v23, v151, v147, s17
    v_dot2_f32_bf16 v8, v16, v50, v8
    v_dot2_f32_bf16 v9, v17, v50, v9
    v_dot2_f32_bf16 v10, v18, v50, v10
    v_dot2_f32_bf16 v11, v19, v50, v11
    v_dot2_f32_bf16 v12, v20, v50, v12
    v_dot2_f32_bf16 v13, v21, v50, v13
    v_dot2_f32_bf16 v14, v22, v50, v14
    v_dot2_f32_bf16 v15, v23, v50, v15
    v_perm_b32 v16, v156, v152, s16
    v_perm_b32 v17, v156, v152, s17
    v_perm_b32 v18, v157, v153, s16
    v_perm_b32 v19, v157, v153, s17
    v_perm_b32 v20, v158, v154, s16
    v_perm_b32 v21, v158, v154, s17
    v_perm_b32 v22, v159, v155, s16
    v_perm_b32 v23, v159, v155, s17
    v_dot2_f32_bf16 v8, v16, v51, v8
    v_dot2_f32_bf16 v9, v17, v51, v9
    v_dot2_f32_bf16 v10, v18, v51, v10
    v_dot2_f32_bf16 v11, v19, v51, v11
    v_dot2_f32_bf16 v12, v20, v51, v12
    v_dot2_f32_bf16 v13, v21, v51, v13
    v_dot2_f32_bf16 v14, v22, v51, v14
    v_dot2_f32_bf16 v15, v23, v51, v15
    v_permlane32_swap_b32 v8, v12
    v_permlane32_swap_b32 v9, v13
    v_permlane32_swap_b32 v10, v14
    v_permlane32_swap_b32 v11, v15
    v_add_f32 v8, v8, v12
    v_add_f32 v9, v9, v13
    v_add_f32 v10, v10, v14
    v_add_f32 v11, v11, v15
    s_nop 0
    v_permlane16_swap_b32 v8, v10
    v_permlane16_swap_b32 v9, v11
    v_add_f32 v8, v8, v10
    v_add_f32 v9, v9, v11
    s_nop 0
    v_add_f32_dpp v10, v8, v8 row_ror:8 row_mask:0xf bank_mask:0x3
    v_add_f32_dpp v10, v9, v9 row_ror:8 row_mask:0xf bank_mask:0xc
    ds_write_b32 v61, v10 offset:29952
    v_perm_b32 v16, v164, v160, s16
    v_perm_b32 v17, v164, v160, s17
    v_perm_b32 v18, v165, v161, s16
    v_perm_b32 v19, v165, v161, s17
    v_perm_b32 v20, v166, v162, s16
    v_perm_b32 v21, v166, v162, s17
    v_perm_b32 v22, v167, v163, s16
    v_perm_b32 v23, v167, v163, s17
    v_dot2_f32_bf16 v8, v16, v48, 0
    v_dot2_f32_bf16 v9, v17, v48, 0
    v_dot2_f32_bf16 v10, v18, v48, 0
    v_dot2_f32_bf16 v11, v19, v48, 0
    v_dot2_f32_bf16 v12, v20, v48, 0
    v_dot2_f32_bf16 v13, v21, v48, 0
    v_dot2_f32_bf16 v14, v22, v48, 0
    v_dot2_f32_bf16 v15, v23, v48, 0
    v_perm_b32 v16, v172, v168, s16
    v_perm_b32 v17, v172, v168, s17
    v_perm_b32 v18, v173, v169, s16
    v_perm_b32 v19, v173, v169, s17
    v_perm_b32 v20, v174, v170, s16
    v_perm_b32 v21, v174, v170, s17
    v_perm_b32 v22, v175, v171, s16
    v_perm_b32 v23, v175, v171, s17
    v_dot2_f32_bf16 v8, v16, v49, v8
    v_dot2_f32_bf16 v9, v17, v49, v9
    v_dot2_f32_bf16 v10, v18, v49, v10
    v_dot2_f32_bf16 v11, v19, v49, v11
    v_dot2_f32_bf16 v12, v20, v49, v12
    v_dot2_f32_bf16 v13, v21, v49, v13
    v_dot2_f32_bf16 v14, v22, v49, v14
    v_dot2_f32_bf16 v15, v23, v49, v15
    v_perm_b32 v16, v180, v176, s16
    v_perm_b32 v17, v180, v176, s17
    v_perm_b32 v18, v181, v177, s16
    v_perm_b32 v19, v181, v177, s17
    v_perm_b32 v20, v182, v178, s16
    v_perm_b32 v21, v182, v178, s17
    v_perm_b32 v22, v183, v179, s16
    v_perm_b32 v23, v183, v179, s17
    v_dot2_f32_bf16 v8, v16, v50, v8
    v_dot2_f32_bf16 v9, v17, v50, v9
    v_dot2_f32_bf16 v10, v18, v50, v10
    v_dot2_f32_bf16 v11, v19, v50, v11
    v_dot2_f32_bf16 v12, v20, v50, v12
    v_dot2_f32_bf16 v13, v21, v50, v13
    v_dot2_f32_bf16 v14, v22, v50, v14
    v_dot2_f32_bf16 v15, v23, v50, v15
    v_perm_b32 v16, v188, v184, s16
    v_perm_b32 v17, v188, v184, s17
    v_perm_b32 v18, v189, v185, s16
    v_perm_b32 v19, v189, v185, s17
    v_perm_b32 v20, v190, v186, s16
    v_perm_b32 v21, v190, v186, s17
    v_perm_b32 v22, v191, v187, s16
    v_perm_b32 v23, v191, v187, s17
    v_dot2_f32_bf16 v8, v16, v51, v8
    v_dot2_f32_bf16 v9, v17, v51, v9
    v_dot2_f32_bf16 v10, v18, v51, v10
    v_dot2_f32_bf16 v11, v19, v51, v11
    v_dot2_f32_bf16 v12, v20, v51, v12
    v_dot2_f32_bf16 v13, v21, v51, v13
    v_dot2_f32_bf16 v14, v22, v51, v14
    v_dot2_f32_bf16 v15, v23, v51, v15
    v_permlane32_swap_b32 v8, v12
    v_permlane32_swap_b32 v9, v13
    v_permlane32_swap_b32 v10, v14
    v_permlane32_swap_b32 v11, v15
    v_add_f32 v8, v8, v12
    v_add_f32 v9, v9, v13
    v_add_f32 v10, v10, v14
    v_add_f32 v11, v11, v15
    s_nop 0
    v_permlane16_swap_b32 v8, v10
    v_permlane16_swap_b32 v9, v11
    v_add_f32 v8, v8, v10
    v_add_f32 v9, v9, v11
    s_nop 0
    v_add_f32_dpp v10, v8, v8 row_ror:8 row_mask:0xf bank_mask:0x3
    v_add_f32_dpp v10, v9, v9 row_ror:8 row_mask:0xf bank_mask:0xc
    ds_write_b32 v61, v10 offset:32000
    s_waitcnt lgkmcnt(0)
    s_barrier
    v_mov_b32 v59, 0
    ds_read_b128 v[8:11], v59 offset:29696
    ds_read_b128 v[12:15], v59 offset:29712
    ds_read_b128 v[16:19], v62 offset:17408
    v_lshlrev_b32 v44, 2, v1
    ds_read_b32 v28, v44 offset:29952
    ds_read_b32 v36, v44 offset:32000
    ds_read_b32 v29, v44 offset:30208
    ds_read_b32 v37, v44 offset:32256
    ds_read_b32 v30, v44 offset:30464
    ds_read_b32 v38, v44 offset:32512
    ds_read_b32 v31, v44 offset:30720
    ds_read_b32 v39, v44 offset:32768
    ds_read_b32 v32, v44 offset:30976
    ds_read_b32 v40, v44 offset:33024
    ds_read_b32 v33, v44 offset:31232
    ds_read_b32 v41, v44 offset:33280
    ds_read_b32 v34, v44 offset:31488
    ds_read_b32 v42, v44 offset:33536
    s_waitcnt lgkmcnt(0)
    v_max3_f32 v8, v8, v9, v10
    v_max3_f32 v8, v8, v11, v12
    v_max3_f32 v8, v8, v13, v14
    v_max_f32 v8, v8, v15
    v_cvt_pk_bf16_f32 v58, v8, v8
    v_lshlrev_b32 v58, 16, v58
    v_cvt_pk_bf16_f32 v16, v16, v16
    v_lshlrev_b32 v16, 16, v16
    v_sub_f32 v16, v16, v58
    v_mul_f32 v16, s18, v16
    v_exp_f32 v16, v16
    v_cvt_pk_bf16_f32 v17, v17, v17
    v_lshlrev_b32 v17, 16, v17
    v_sub_f32 v17, v17, v58
    v_mul_f32 v17, s18, v17
    v_exp_f32 v17, v17
    v_cvt_pk_bf16_f32 v18, v18, v18
    v_lshlrev_b32 v18, 16, v18
    v_sub_f32 v18, v18, v58
    v_mul_f32 v18, s18, v18
    v_exp_f32 v18, v18
    v_cvt_pk_bf16_f32 v19, v19, v19
    v_lshlrev_b32 v19, 16, v19
    v_sub_f32 v19, v19, v58
    v_mul_f32 v19, s18, v19
    v_exp_f32 v19, v19
    v_add_f32 v20, v16, v17
    v_add_f32 v20, v20, v18
    v_add_f32 v20, v20, v19
    v_cvt_pk_bf16_f32 v16, v16, v17
    v_cvt_pk_bf16_f32 v17, v18, v19
    s_lshl_b32 s15, s7, 9
    v_lshlrev_b32 v21, 3, v1
    v_add_u32 v21, s15, v21
    ds_write_b64 v21, v[16:17] offset:25600
    v_add_f32_dpp v20, v20, v20 quad_perm:[1,0,3,2] row_mask:0xf bank_mask:0xf
    s_nop 1
    v_add_f32_dpp v20, v20, v20 quad_perm:[2,3,0,1] row_mask:0xf bank_mask:0xf
    s_nop 1
    v_add_f32_dpp v20, v20, v20 row_half_mirror row_mask:0xf bank_mask:0xf
    s_nop 1
    v_add_f32_dpp v20, v20, v20 row_mirror row_mask:0xf bank_mask:0xf
    v_mov_b32 v22, v20
    s_nop 1
    v_permlane16_swap_b32 v20, v22
    v_add_f32 v20, v20, v22
    v_mov_b32 v22, v20
    s_nop 1
    v_permlane32_swap_b32 v20, v22
    v_add_f32 v20, v20, v22
    s_lshl_b32 s14, s7, 2
    v_mov_b32 v59, s14
    ds_write_b32 v59, v20 offset:29728
    v_lshlrev_b32 v57, 8, v56
    v_add_u32 v57, s15, v57
    v_add_f32 v28, v28, v29
    v_add_f32 v36, v36, v37
    v_add_f32 v28, v28, v30
    v_add_f32 v36, v36, v38
    v_add_f32 v28, v28, v31
    v_add_f32 v36, v36, v39
    v_add_f32 v28, v28, v32
    v_add_f32 v36, v36, v40
    v_add_f32 v28, v28, v33
    v_add_f32 v36, v36, v41
    v_add_f32 v28, v28, v34
    v_add_f32 v36, v36, v42
    v_cvt_pk_bf16_f32 v28, v28, v28
    v_lshlrev_b32 v28, 16, v28
    v_cvt_pk_bf16_f32 v36, v36, v36
    v_lshlrev_b32 v36, 16, v36
    v_mul_f32 v28, 0xbfb8aa3b, v28
    v_exp_f32 v28, v28
    s_nop 0
    v_add_f32 v28, 1.0, v28
    v_rcp_f32 v29, v28
    s_nop 0
    v_fma_f32 v30, -v28, v29, 1.0
    v_fma_f32 v30, v30, v29, v29
    v_cmp_o_f32 vcc, v30, v30
    s_nop 1
    v_cndmask_b32 v29, v29, v30, vcc
    v_cvt_pk_bf16_f32 v29, v29, v29
    v_lshlrev_b32 v29, 16, v29
    v_mul_f32 v29, v29, v36
    v_cvt_pk_bf16_f32 v29, v29, v29
    v_cmp_gt_u32 vcc, 56, v1
    s_nop 1
    v_cndmask_b32 v29, 0, v29, vcc
    s_lshl_b32 s14, s7, 7
    v_lshlrev_b32 v30, 1, v1
    v_add_u32 v30, s14, v30
    ds_write_b16 v30, v29 offset:34048
    v_lshlrev_b32 v31, 4, v52
    v_add_u32 v31, s14, v31
    s_waitcnt lgkmcnt(0)
    ds_read_b128 v[48:51], v31 offset:34048
    ds_read_b128 v[24:27], v57 offset:25600
    ds_read_b128 v[28:31], v57 offset:25616
    s_waitcnt lgkmcnt(0)
    v_perm_b32 v16, v196, v192, s16
    v_perm_b32 v17, v196, v192, s17
    v_perm_b32 v18, v197, v193, s16
    v_perm_b32 v19, v197, v193, s17
    v_perm_b32 v20, v198, v194, s16
    v_perm_b32 v21, v198, v194, s17
    v_perm_b32 v22, v199, v195, s16
    v_perm_b32 v23, v199, v195, s17
    v_dot2_f32_bf16 v8, v16, v48, 0
    v_dot2_f32_bf16 v9, v17, v48, 0
    v_dot2_f32_bf16 v10, v18, v48, 0
    v_dot2_f32_bf16 v11, v19, v48, 0
    v_dot2_f32_bf16 v12, v20, v48, 0
    v_dot2_f32_bf16 v13, v21, v48, 0
    v_dot2_f32_bf16 v14, v22, v48, 0
    v_dot2_f32_bf16 v15, v23, v48, 0
    v_perm_b32 v16, v204, v200, s16
    v_perm_b32 v17, v204, v200, s17
    v_perm_b32 v18, v205, v201, s16
    v_perm_b32 v19, v205, v201, s17
    v_perm_b32 v20, v206, v202, s16
    v_perm_b32 v21, v206, v202, s17
    v_perm_b32 v22, v207, v203, s16
    v_perm_b32 v23, v207, v203, s17
    v_dot2_f32_bf16 v8, v16, v49, v8
    v_dot2_f32_bf16 v9, v17, v49, v9
    v_dot2_f32_bf16 v10, v18, v49, v10
    v_dot2_f32_bf16 v11, v19, v49, v11
    v_dot2_f32_bf16 v12, v20, v49, v12
    v_dot2_f32_bf16 v13, v21, v49, v13
    v_dot2_f32_bf16 v14, v22, v49, v14
    v_dot2_f32_bf16 v15, v23, v49, v15
    v_perm_b32 v16, v212, v208, s16
    v_perm_b32 v17, v212, v208, s17
    v_perm_b32 v18, v213, v209, s16
    v_perm_b32 v19, v213, v209, s17
    v_perm_b32 v20, v214, v210, s16
    v_perm_b32 v21, v214, v210, s17
    v_perm_b32 v22, v215, v211, s16
    v_perm_b32 v23, v215, v211, s17
    v_dot2_f32_bf16 v8, v16, v50, v8
    v_dot2_f32_bf16 v9, v17, v50, v9
    v_dot2_f32_bf16 v10, v18, v50, v10
    v_dot2_f32_bf16 v11, v19, v50, v11
    v_dot2_f32_bf16 v12, v20, v50, v12
    v_dot2_f32_bf16 v13, v21, v50, v13
    v_dot2_f32_bf16 v14, v22, v50, v14
    v_dot2_f32_bf16 v15, v23, v50, v15
    v_perm_b32 v16, v220, v216, s16
    v_perm_b32 v17, v220, v216, s17
    v_perm_b32 v18, v221, v217, s16
    v_perm_b32 v19, v221, v217, s17
    v_perm_b32 v20, v222, v218, s16
    v_perm_b32 v21, v222, v218, s17
    v_perm_b32 v22, v223, v219, s16
    v_perm_b32 v23, v223, v219, s17
    v_dot2_f32_bf16 v8, v16, v51, v8
    v_dot2_f32_bf16 v9, v17, v51, v9
    v_dot2_f32_bf16 v10, v18, v51, v10
    v_dot2_f32_bf16 v11, v19, v51, v11
    v_dot2_f32_bf16 v12, v20, v51, v12
    v_dot2_f32_bf16 v13, v21, v51, v13
    v_dot2_f32_bf16 v14, v22, v51, v14
    v_dot2_f32_bf16 v15, v23, v51, v15
    v_permlane32_swap_b32 v8, v12
    v_permlane32_swap_b32 v9, v13
    v_permlane32_swap_b32 v10, v14
    v_permlane32_swap_b32 v11, v15
    v_add_f32 v8, v8, v12
    v_add_f32 v9, v9, v13
    v_add_f32 v10, v10, v14
    v_add_f32 v11, v11, v15
    s_nop 0
    v_permlane16_swap_b32 v8, v10
    v_permlane16_swap_b32 v9, v11
    v_add_f32 v8, v8, v10
    v_add_f32 v9, v9, v11
    s_nop 0
    v_add_f32_dpp v10, v8, v8 row_ror:8 row_mask:0xf bank_mask:0x3
    v_add_f32_dpp v10, v9, v9 row_ror:8 row_mask:0xf bank_mask:0xc
    s_mul_i32 s6, s6, 1792
    s_add_u32 s14, s6, 524288
    s_cmp_eq_u32 s7, 7
    s_cselect_b32 s14, 0x40000000, s14
    buffer_store_dword v10, v61, s[76:79], s14 offen sc1
    v_lshrrev_b32 v45, 4, v1
    v_and_b32 v46, 15, v1
    v_mul_u32_u24 v42, 14336, v45
    v_lshl_add_u32 v42, v46, 4, v42
    s_lshl_b32 s15, s7, 8
    v_add_u32 v42, s15, v42
    v_lshl_add_u32 v40, v46, 2, v45
    s_lshl_b32 s15, s7, 6
    v_add_u32 v40, s15, v40
    v_lshlrev_b32 v40, 1, v40
    buffer_load_ushort v41, v40, s[40:43], 0 offen
    v_and_b32 v44, 31, v1
    v_lshlrev_b32 v44, 3, v44
    v_lshlrev_b32 v43, 5, v45
    s_nop 3
L_vgo:
    v_perm_b32 v16, v100, v96, s16
    v_perm_b32 v17, v100, v96, s17
    v_perm_b32 v18, v101, v97, s16
    v_perm_b32 v19, v101, v97, s17
    v_perm_b32 v20, v102, v98, s16
    v_perm_b32 v21, v102, v98, s17
    v_perm_b32 v22, v103, v99, s16
    v_perm_b32 v23, v103, v99, s17
    v_dot2_f32_bf16 v8, v16, v24, 0
    v_dot2_f32_bf16 v9, v17, v24, 0
    v_dot2_f32_bf16 v10, v18, v24, 0
    v_dot2_f32_bf16 v11, v19, v24, 0
    v_dot2_f32_bf16 v12, v20, v24, 0
    v_dot2_f32_bf16 v13, v21, v24, 0
    v_dot2_f32_bf16 v14, v22, v24, 0
    v_dot2_f32_bf16 v15, v23, v24, 0
    s_add_u32 s9, s9, s21
    buffer_load_dwordx4 v[96:99], v3, s[48:51], s9 offen offset:0 nt
    s_mov_b32 s19, 0
    buffer_load_dwordx4 v[128:131], v54, s[60:63], s19 offen offset:0
    buffer_load_dwordx4 v[100:103], v3, s[48:51], s9 offen offset:1024 nt
    v_perm_b32 v16, v108, v104, s16
    v_perm_b32 v17, v108, v104, s17
    v_perm_b32 v18, v109, v105, s16
    v_perm_b32 v19, v109, v105, s17
    v_perm_b32 v20, v110, v106, s16
    v_perm_b32 v21, v110, v106, s17
    v_perm_b32 v22, v111, v107, s16
    v_perm_b32 v23, v111, v107, s17
    v_dot2_f32_bf16 v8, v16, v25, v8
    v_dot2_f32_bf16 v9, v17, v25, v9
    v_dot2_f32_bf16 v10, v18, v25, v10
    v_dot2_f32_bf16 v11, v19, v25, v11
    v_dot2_f32_bf16 v12, v20, v25, v12
    v_dot2_f32_bf16 v13, v21, v25, v13
    v_dot2_f32_bf16 v14, v22, v25, v14
    v_dot2_f32_bf16 v15, v23, v25, v15
    buffer_load_dwordx4 v[104:107], v3, s[48:51], s9 offen offset:2048 nt
    buffer_load_dwordx4 v[108:111], v3, s[48:51], s9 offen offset:3072 nt
    buffer_load_dwordx4 v[132:135], v54, s[60:63], s19 offen offset:896
    v_perm_b32 v16, v116, v112, s16
    v_perm_b32 v17, v116, v112, s17
    v_perm_b32 v18, v117, v113, s16
    v_perm_b32 v19, v117, v113, s17
    v_perm_b32 v20, v118, v114, s16
    v_perm_b32 v21, v118, v114, s17
    v_perm_b32 v22, v119, v115, s16
    v_perm_b32 v23, v119, v115, s17
    v_dot2_f32_bf16 v8, v16, v26, v8
    v_dot2_f32_bf16 v9, v17, v26, v9
    v_dot2_f32_bf16 v10, v18, v26, v10
    v_dot2_f32_bf16 v11, v19, v26, v11
    v_dot2_f32_bf16 v12, v20, v26, v12
    v_dot2_f32_bf16 v13, v21, v26, v13
    v_dot2_f32_bf16 v14, v22, v26, v14
    v_dot2_f32_bf16 v15, v23, v26, v15
    s_add_u32 s10, s10, s21
    buffer_load_dwordx4 v[112:115], v3, s[48:51], s10 offen offset:0 nt
    buffer_load_dwordx4 v[116:119], v3, s[48:51], s10 offen offset:1024 nt
    v_perm_b32 v16, v124, v120, s16
    v_perm_b32 v17, v124, v120, s17
    v_perm_b32 v18, v125, v121, s16
    v_perm_b32 v19, v125, v121, s17
    v_perm_b32 v20, v126, v122, s16
    v_perm_b32 v21, v126, v122, s17
    v_perm_b32 v22, v127, v123, s16
    v_perm_b32 v23, v127, v123, s17
    v_dot2_f32_bf16 v8, v16, v27, v8
    v_dot2_f32_bf16 v9, v17, v27, v9
    v_dot2_f32_bf16 v10, v18, v27, v10
    v_dot2_f32_bf16 v11, v19, v27, v11
    v_dot2_f32_bf16 v12, v20, v27, v12
    v_dot2_f32_bf16 v13, v21, v27, v13
    v_dot2_f32_bf16 v14, v22, v27, v14
    v_dot2_f32_bf16 v15, v23, v27, v15
    buffer_load_dwordx4 v[120:123], v3, s[48:51], s10 offen offset:2048 nt
    buffer_load_dwordx4 v[124:127], v3, s[48:51], s10 offen offset:3072 nt
    buffer_load_dwordx4 v[136:139], v54, s[60:63], s19 offen offset:1792
    ds_read_b128 v[24:27], v57 offset:25632
    s_waitcnt lgkmcnt(1)
    v_perm_b32 v16, v68, v64, s16
    v_perm_b32 v17, v68, v64, s17
    v_perm_b32 v18, v69, v65, s16
    v_perm_b32 v19, v69, v65, s17
    v_perm_b32 v20, v70, v66, s16
    v_perm_b32 v21, v70, v66, s17
    v_perm_b32 v22, v71, v67, s16
    v_perm_b32 v23, v71, v67, s17
    v_dot2_f32_bf16 v8, v16, v28, v8
    v_dot2_f32_bf16 v9, v17, v28, v9
    v_dot2_f32_bf16 v10, v18, v28, v10
    v_dot2_f32_bf16 v11, v19, v28, v11
    v_dot2_f32_bf16 v12, v20, v28, v12
    v_dot2_f32_bf16 v13, v21, v28, v13
    v_dot2_f32_bf16 v14, v22, v28, v14
    v_dot2_f32_bf16 v15, v23, v28, v15
    s_add_u32 s11, s11, s21
    buffer_load_dwordx4 v[64:67], v3, s[48:51], s11 offen offset:0 nt
    buffer_load_dwordx4 v[68:71], v3, s[48:51], s11 offen offset:1024 nt
    v_perm_b32 v16, v76, v72, s16
    v_perm_b32 v17, v76, v72, s17
    v_perm_b32 v18, v77, v73, s16
    v_perm_b32 v19, v77, v73, s17
    v_perm_b32 v20, v78, v74, s16
    v_perm_b32 v21, v78, v74, s17
    v_perm_b32 v22, v79, v75, s16
    v_perm_b32 v23, v79, v75, s17
    v_dot2_f32_bf16 v8, v16, v29, v8
    v_dot2_f32_bf16 v9, v17, v29, v9
    v_dot2_f32_bf16 v10, v18, v29, v10
    v_dot2_f32_bf16 v11, v19, v29, v11
    v_dot2_f32_bf16 v12, v20, v29, v12
    v_dot2_f32_bf16 v13, v21, v29, v13
    v_dot2_f32_bf16 v14, v22, v29, v14
    v_dot2_f32_bf16 v15, v23, v29, v15
    buffer_load_dwordx4 v[72:75], v3, s[48:51], s11 offen offset:2048 nt
    buffer_load_dwordx4 v[76:79], v3, s[48:51], s11 offen offset:3072 nt
    buffer_load_dwordx4 v[140:143], v54, s[60:63], s19 offen offset:2688
    s_add_u32 s19, s19, s20
    s_waitcnt vmcnt(20)
    v_perm_b32 v16, v84, v80, s16
    v_perm_b32 v17, v84, v80, s17
    v_perm_b32 v18, v85, v81, s16
    v_perm_b32 v19, v85, v81, s17
    v_perm_b32 v20, v86, v82, s16
    v_perm_b32 v21, v86, v82, s17
    v_perm_b32 v22, v87, v83, s16
    v_perm_b32 v23, v87, v83, s17
    v_dot2_f32_bf16 v8, v16, v30, v8
    v_dot2_f32_bf16 v9, v17, v30, v9
    v_dot2_f32_bf16 v10, v18, v30, v10
    v_dot2_f32_bf16 v11, v19, v30, v11
    v_dot2_f32_bf16 v12, v20, v30, v12
    v_dot2_f32_bf16 v13, v21, v30, v13
    v_dot2_f32_bf16 v14, v22, v30, v14
    v_dot2_f32_bf16 v15, v23, v30, v15
    s_add_u32 s12, s12, s21
    buffer_load_dwordx4 v[80:83], v3, s[48:51], s12 offen offset:0 nt
    buffer_load_dwordx4 v[84:87], v3, s[48:51], s12 offen offset:1024 nt
    s_waitcnt vmcnt(20)
    v_perm_b32 v16, v92, v88, s16
    v_perm_b32 v17, v92, v88, s17
    v_perm_b32 v18, v93, v89, s16
    v_perm_b32 v19, v93, v89, s17
    v_perm_b32 v20, v94, v90, s16
    v_perm_b32 v21, v94, v90, s17
    v_perm_b32 v22, v95, v91, s16
    v_perm_b32 v23, v95, v91, s17
    v_dot2_f32_bf16 v8, v16, v31, v8
    v_dot2_f32_bf16 v9, v17, v31, v9
    v_dot2_f32_bf16 v10, v18, v31, v10
    v_dot2_f32_bf16 v11, v19, v31, v11
    v_dot2_f32_bf16 v12, v20, v31, v12
    v_dot2_f32_bf16 v13, v21, v31, v13
    v_dot2_f32_bf16 v14, v22, v31, v14
    v_dot2_f32_bf16 v15, v23, v31, v15
    buffer_load_dwordx4 v[88:91], v3, s[48:51], s12 offen offset:2048 nt
    buffer_load_dwordx4 v[92:95], v3, s[48:51], s12 offen offset:3072 nt
    buffer_load_dwordx4 v[144:147], v54, s[60:63], s19 offen offset:0
    ds_read_b128 v[28:31], v57 offset:25648
    s_waitcnt vmcnt(18) lgkmcnt(1)
    v_perm_b32 v16, v100, v96, s16
    v_perm_b32 v17, v100, v96, s17
    v_perm_b32 v18, v101, v97, s16
    v_perm_b32 v19, v101, v97, s17
    v_perm_b32 v20, v102, v98, s16
    v_perm_b32 v21, v102, v98, s17
    v_perm_b32 v22, v103, v99, s16
    v_perm_b32 v23, v103, v99, s17
    v_dot2_f32_bf16 v8, v16, v24, v8
    v_dot2_f32_bf16 v9, v17, v24, v9
    v_dot2_f32_bf16 v10, v18, v24, v10
    v_dot2_f32_bf16 v11, v19, v24, v11
    v_dot2_f32_bf16 v12, v20, v24, v12
    v_dot2_f32_bf16 v13, v21, v24, v13
    v_dot2_f32_bf16 v14, v22, v24, v14
    v_dot2_f32_bf16 v15, v23, v24, v15
    s_add_u32 s9, s9, s21
    buffer_load_dwordx4 v[96:99], v3, s[48:51], s9 offen offset:0 nt
    buffer_load_dwordx4 v[100:103], v3, s[48:51], s9 offen offset:1024 nt
    s_waitcnt vmcnt(18)
    v_perm_b32 v16, v108, v104, s16
    v_perm_b32 v17, v108, v104, s17
    v_perm_b32 v18, v109, v105, s16
    v_perm_b32 v19, v109, v105, s17
    v_perm_b32 v20, v110, v106, s16
    v_perm_b32 v21, v110, v106, s17
    v_perm_b32 v22, v111, v107, s16
    v_perm_b32 v23, v111, v107, s17
    v_dot2_f32_bf16 v8, v16, v25, v8
    v_dot2_f32_bf16 v9, v17, v25, v9
    v_dot2_f32_bf16 v10, v18, v25, v10
    v_dot2_f32_bf16 v11, v19, v25, v11
    v_dot2_f32_bf16 v12, v20, v25, v12
    v_dot2_f32_bf16 v13, v21, v25, v13
    v_dot2_f32_bf16 v14, v22, v25, v14
    v_dot2_f32_bf16 v15, v23, v25, v15
    buffer_load_dwordx4 v[104:107], v3, s[48:51], s9 offen offset:2048 nt
    buffer_load_dwordx4 v[148:151], v54, s[60:63], s19 offen offset:896
    buffer_load_dwordx4 v[108:111], v3, s[48:51], s9 offen offset:3072 nt
    s_waitcnt vmcnt(18)
    v_perm_b32 v16, v116, v112, s16
    v_perm_b32 v17, v116, v112, s17
    v_perm_b32 v18, v117, v113, s16
    v_perm_b32 v19, v117, v113, s17
    v_perm_b32 v20, v118, v114, s16
    v_perm_b32 v21, v118, v114, s17
    v_perm_b32 v22, v119, v115, s16
    v_perm_b32 v23, v119, v115, s17
    v_dot2_f32_bf16 v8, v16, v26, v8
    v_dot2_f32_bf16 v9, v17, v26, v9
    v_dot2_f32_bf16 v10, v18, v26, v10
    v_dot2_f32_bf16 v11, v19, v26, v11
    v_dot2_f32_bf16 v12, v20, v26, v12
    v_dot2_f32_bf16 v13, v21, v26, v13
    v_dot2_f32_bf16 v14, v22, v26, v14
    v_dot2_f32_bf16 v15, v23, v26, v15
    s_add_u32 s10, s10, s21
    buffer_load_dwordx4 v[112:115], v3, s[48:51], s10 offen offset:0 nt
    buffer_load_dwordx4 v[116:119], v3, s[48:51], s10 offen offset:1024 nt
    v_perm_b32 v63, v132, v128, s16
    v_perm_b32 v132, v132, v128, s17
    v_perm_b32 v128, v133, v129, s16
    v_perm_b32 v133, v133, v129, s17
    v_perm_b32 v129, v134, v130, s16
    v_perm_b32 v134, v134, v130, s17
    v_perm_b32 v130, v135, v131, s16
    v_perm_b32 v135, v135, v131, s17
    s_waitcnt vmcnt(18)
    v_perm_b32 v16, v124, v120, s16
    v_perm_b32 v17, v124, v120, s17
    v_perm_b32 v18, v125, v121, s16
    v_perm_b32 v19, v125, v121, s17
    v_perm_b32 v20, v126, v122, s16
    v_perm_b32 v21, v126, v122, s17
    v_perm_b32 v22, v127, v123, s16
    v_perm_b32 v23, v127, v123, s17
    v_dot2_f32_bf16 v8, v16, v27, v8
    v_dot2_f32_bf16 v9, v17, v27, v9
    v_dot2_f32_bf16 v10, v18, v27, v10
    v_dot2_f32_bf16 v11, v19, v27, v11
    v_dot2_f32_bf16 v12, v20, v27, v12
    v_dot2_f32_bf16 v13, v21, v27, v13
    v_dot2_f32_bf16 v14, v22, v27, v14
    v_dot2_f32_bf16 v15, v23, v27, v15
    buffer_load_dwordx4 v[120:123], v3, s[48:51], s10 offen offset:2048 nt
    buffer_load_dwordx4 v[152:155], v54, s[60:63], s19 offen offset:1792
    buffer_load_dwordx4 v[124:127], v3, s[48:51], s10 offen offset:3072 nt
    ds_read_b128 v[24:27], v57 offset:25664
    s_waitcnt vmcnt(18) lgkmcnt(1)
    v_perm_b32 v16, v68, v64, s16
    v_perm_b32 v17, v68, v64, s17
    v_perm_b32 v18, v69, v65, s16
    v_perm_b32 v19, v69, v65, s17
    v_perm_b32 v20, v70, v66, s16
    v_perm_b32 v21, v70, v66, s17
    v_perm_b32 v22, v71, v67, s16
    v_perm_b32 v23, v71, v67, s17
    v_dot2_f32_bf16 v8, v16, v28, v8
    v_dot2_f32_bf16 v9, v17, v28, v9
    v_dot2_f32_bf16 v10, v18, v28, v10
    v_dot2_f32_bf16 v11, v19, v28, v11
    v_dot2_f32_bf16 v12, v20, v28, v12
    v_dot2_f32_bf16 v13, v21, v28, v13
    v_dot2_f32_bf16 v14, v22, v28, v14
    v_dot2_f32_bf16 v15, v23, v28, v15
    s_add_u32 s11, s11, s21
    buffer_load_dwordx4 v[64:67], v3, s[48:51], s11 offen offset:0 nt
    buffer_load_dwordx4 v[68:71], v3, s[48:51], s11 offen offset:1024 nt
    s_waitcnt vmcnt(18)
    v_perm_b32 v16, v76, v72, s16
    v_perm_b32 v17, v76, v72, s17
    v_perm_b32 v18, v77, v73, s16
    v_perm_b32 v19, v77, v73, s17
    v_perm_b32 v20, v78, v74, s16
    v_perm_b32 v21, v78, v74, s17
    v_perm_b32 v22, v79, v75, s16
    v_perm_b32 v23, v79, v75, s17
    v_dot2_f32_bf16 v8, v16, v29, v8
    v_dot2_f32_bf16 v9, v17, v29, v9
    v_dot2_f32_bf16 v10, v18, v29, v10
    v_dot2_f32_bf16 v11, v19, v29, v11
    v_dot2_f32_bf16 v12, v20, v29, v12
    v_dot2_f32_bf16 v13, v21, v29, v13
    v_dot2_f32_bf16 v14, v22, v29, v14
    v_dot2_f32_bf16 v15, v23, v29, v15
    buffer_load_dwordx4 v[72:75], v3, s[48:51], s11 offen offset:2048 nt
    buffer_load_dwordx4 v[156:159], v54, s[60:63], s19 offen offset:2688
    s_add_u32 s19, s19, s20
    buffer_load_dwordx4 v[76:79], v3, s[48:51], s11 offen offset:3072 nt
    s_waitcnt vmcnt(18)
    v_perm_b32 v16, v84, v80, s16
    v_perm_b32 v17, v84, v80, s17
    v_perm_b32 v18, v85, v81, s16
    v_perm_b32 v19, v85, v81, s17
    v_perm_b32 v20, v86, v82, s16
    v_perm_b32 v21, v86, v82, s17
    v_perm_b32 v22, v87, v83, s16
    v_perm_b32 v23, v87, v83, s17
    v_dot2_f32_bf16 v8, v16, v30, v8
    v_dot2_f32_bf16 v9, v17, v30, v9
    v_dot2_f32_bf16 v10, v18, v30, v10
    v_dot2_f32_bf16 v11, v19, v30, v11
    v_dot2_f32_bf16 v12, v20, v30, v12
    v_dot2_f32_bf16 v13, v21, v30, v13
    v_dot2_f32_bf16 v14, v22, v30, v14
    v_dot2_f32_bf16 v15, v23, v30, v15
    s_add_u32 s12, s12, s21
    buffer_load_dwordx4 v[80:83], v3, s[48:51], s12 offen offset:0 nt
    buffer_load_dwordx4 v[84:87], v3, s[48:51], s12 offen offset:1024 nt
    v_perm_b32 v131, v140, v136, s16
    v_perm_b32 v140, v140, v136, s17
    v_perm_b32 v136, v141, v137, s16
    v_perm_b32 v141, v141, v137, s17
    v_perm_b32 v137, v142, v138, s16
    v_perm_b32 v142, v142, v138, s17
    v_perm_b32 v138, v143, v139, s16
    v_perm_b32 v143, v143, v139, s17
    s_waitcnt vmcnt(18)
    v_perm_b32 v16, v92, v88, s16
    v_perm_b32 v17, v92, v88, s17
    v_perm_b32 v18, v93, v89, s16
    v_perm_b32 v19, v93, v89, s17
    v_perm_b32 v20, v94, v90, s16
    v_perm_b32 v21, v94, v90, s17
    v_perm_b32 v22, v95, v91, s16
    v_perm_b32 v23, v95, v91, s17
    v_dot2_f32_bf16 v8, v16, v31, v8
    v_dot2_f32_bf16 v9, v17, v31, v9
    v_dot2_f32_bf16 v10, v18, v31, v10
    v_dot2_f32_bf16 v11, v19, v31, v11
    v_dot2_f32_bf16 v12, v20, v31, v12
    v_dot2_f32_bf16 v13, v21, v31, v13
    v_dot2_f32_bf16 v14, v22, v31, v14
    v_dot2_f32_bf16 v15, v23, v31, v15
    buffer_load_dwordx4 v[88:91], v3, s[48:51], s12 offen offset:2048 nt
    buffer_load_dwordx4 v[160:163], v54, s[60:63], s19 offen offset:0
    buffer_load_dwordx4 v[92:95], v3, s[48:51], s12 offen offset:3072 nt
    ds_read_b128 v[28:31], v57 offset:25680
    s_waitcnt vmcnt(18) lgkmcnt(1)
    v_perm_b32 v16, v100, v96, s16
    v_perm_b32 v17, v100, v96, s17
    v_perm_b32 v18, v101, v97, s16
    v_perm_b32 v19, v101, v97, s17
    v_perm_b32 v20, v102, v98, s16
    v_perm_b32 v21, v102, v98, s17
    v_perm_b32 v22, v103, v99, s16
    v_perm_b32 v23, v103, v99, s17
    v_dot2_f32_bf16 v8, v16, v24, v8
    v_dot2_f32_bf16 v9, v17, v24, v9
    v_dot2_f32_bf16 v10, v18, v24, v10
    v_dot2_f32_bf16 v11, v19, v24, v11
    v_dot2_f32_bf16 v12, v20, v24, v12
    v_dot2_f32_bf16 v13, v21, v24, v13
    v_dot2_f32_bf16 v14, v22, v24, v14
    v_dot2_f32_bf16 v15, v23, v24, v15
    s_add_u32 s9, s9, s21
    buffer_load_dwordx4 v[96:99], v3, s[48:51], s9 offen offset:0 nt
    buffer_load_dwordx4 v[100:103], v3, s[48:51], s9 offen offset:1024 nt
    buffer_load_dwordx4 v[164:167], v54, s[60:63], s19 offen offset:896
    s_waitcnt vmcnt(18)
    v_perm_b32 v16, v108, v104, s16
    v_perm_b32 v17, v108, v104, s17
    v_perm_b32 v18, v109, v105, s16
    v_perm_b32 v19, v109, v105, s17
    v_perm_b32 v20, v110, v106, s16
    v_perm_b32 v21, v110, v106, s17
    v_perm_b32 v22, v111, v107, s16
    v_perm_b32 v23, v111, v107, s17
    v_dot2_f32_bf16 v8, v16, v25, v8
    v_dot2_f32_bf16 v9, v17, v25, v9
    v_dot2_f32_bf16 v10, v18, v25, v10
    v_dot2_f32_bf16 v11, v19, v25, v11
    v_dot2_f32_bf16 v12, v20, v25, v12
    v_dot2_f32_bf16 v13, v21, v25, v13
    v_dot2_f32_bf16 v14, v22, v25, v14
    v_dot2_f32_bf16 v15, v23, v25, v15
    buffer_load_dwordx4 v[104:107], v3, s[48:51], s9 offen offset:2048 nt
    buffer_load_dwordx4 v[108:111], v3, s[48:51], s9 offen offset:3072 nt
    v_perm_b32 v139, v148, v144, s16
    v_perm_b32 v148, v148, v144, s17
    v_perm_b32 v144, v149, v145, s16
    v_perm_b32 v149, v149, v145, s17
    v_perm_b32 v145, v150, v146, s16
    v_perm_b32 v150, v150, v146, s17
    v_perm_b32 v146, v151, v147, s16
    v_perm_b32 v151, v151, v147, s17
    s_waitcnt vmcnt(18)
    v_perm_b32 v16, v116, v112, s16
    v_perm_b32 v17, v116, v112, s17
    v_perm_b32 v18, v117, v113, s16
    v_perm_b32 v19, v117, v113, s17
    v_perm_b32 v20, v118, v114, s16
    v_perm_b32 v21, v118, v114, s17
    v_perm_b32 v22, v119, v115, s16
    v_perm_b32 v23, v119, v115, s17
    v_dot2_f32_bf16 v8, v16, v26, v8
    v_dot2_f32_bf16 v9, v17, v26, v9
    v_dot2_f32_bf16 v10, v18, v26, v10
    v_dot2_f32_bf16 v11, v19, v26, v11
    v_dot2_f32_bf16 v12, v20, v26, v12
    v_dot2_f32_bf16 v13, v21, v26, v13
    v_dot2_f32_bf16 v14, v22, v26, v14
    v_dot2_f32_bf16 v15, v23, v26, v15
    s_add_u32 s10, s10, s21
    buffer_load_dwordx4 v[112:115], v3, s[48:51], s10 offen offset:0 nt
    buffer_load_dwordx4 v[116:119], v3, s[48:51], s10 offen offset:1024 nt
    buffer_load_dwordx4 v[168:171], v54, s[60:63], s19 offen offset:1792
    s_waitcnt vmcnt(18)
    v_perm_b32 v16, v124, v120, s16
    v_perm_b32 v17, v124, v120, s17
    v_perm_b32 v18, v125, v121, s16
    v_perm_b32 v19, v125, v121, s17
    v_perm_b32 v20, v126, v122, s16
    v_perm_b32 v21, v126, v122, s17
    v_perm_b32 v22, v127, v123, s16
    v_perm_b32 v23, v127, v123, s17
    v_dot2_f32_bf16 v8, v16, v27, v8
    v_dot2_f32_bf16 v9, v17, v27, v9
    v_dot2_f32_bf16 v10, v18, v27, v10
    v_dot2_f32_bf16 v11, v19, v27, v11
    v_dot2_f32_bf16 v12, v20, v27, v12
    v_dot2_f32_bf16 v13, v21, v27, v13
    v_dot2_f32_bf16 v14, v22, v27, v14
    v_dot2_f32_bf16 v15, v23, v27, v15
    buffer_load_dwordx4 v[120:123], v3, s[48:51], s10 offen offset:2048 nt
    buffer_load_dwordx4 v[124:127], v3, s[48:51], s10 offen offset:3072 nt
    ds_read_b128 v[24:27], v57 offset:25696
    s_waitcnt vmcnt(18) lgkmcnt(1)
    v_perm_b32 v16, v68, v64, s16
    v_perm_b32 v17, v68, v64, s17
    v_perm_b32 v18, v69, v65, s16
    v_perm_b32 v19, v69, v65, s17
    v_perm_b32 v20, v70, v66, s16
    v_perm_b32 v21, v70, v66, s17
    v_perm_b32 v22, v71, v67, s16
    v_perm_b32 v23, v71, v67, s17
    v_dot2_f32_bf16 v8, v16, v28, v8
    v_dot2_f32_bf16 v9, v17, v28, v9
    v_dot2_f32_bf16 v10, v18, v28, v10
    v_dot2_f32_bf16 v11, v19, v28, v11
    v_dot2_f32_bf16 v12, v20, v28, v12
    v_dot2_f32_bf16 v13, v21, v28, v13
    v_dot2_f32_bf16 v14, v22, v28, v14
    v_dot2_f32_bf16 v15, v23, v28, v15
    s_add_u32 s11, s11, s21
    buffer_load_dwordx4 v[64:67], v3, s[48:51], s11 offen offset:0 nt
    buffer_load_dwordx4 v[68:71], v3, s[48:51], s11 offen offset:1024 nt
    buffer_load_dwordx4 v[172:175], v54, s[60:63], s19 offen offset:2688
    s_add_u32 s19, s19, s20
    s_waitcnt vmcnt(18)
    v_perm_b32 v16, v76, v72, s16
    v_perm_b32 v17, v76, v72, s17
    v_perm_b32 v18, v77, v73, s16
    v_perm_b32 v19, v77, v73, s17
    v_perm_b32 v20, v78, v74, s16
    v_perm_b32 v21, v78, v74, s17
    v_perm_b32 v22, v79, v75, s16
    v_perm_b32 v23, v79, v75, s17
    v_dot2_f32_bf16 v8, v16, v29, v8
    v_dot2_f32_bf16 v9, v17, v29, v9
    v_dot2_f32_bf16 v10, v18, v29, v10
    v_dot2_f32_bf16 v11, v19, v29, v11
    v_dot2_f32_bf16 v12, v20, v29, v12
    v_dot2_f32_bf16 v13, v21, v29, v13
    v_dot2_f32_bf16 v14, v22, v29, v14
    v_dot2_f32_bf16 v15, v23, v29, v15
    buffer_load_dwordx4 v[72:75], v3, s[48:51], s11 offen offset:2048 nt
    buffer_load_dwordx4 v[76:79], v3, s[48:51], s11 offen offset:3072 nt
    v_perm_b32 v147, v156, v152, s16
    v_perm_b32 v156, v156, v152, s17
    v_perm_b32 v152, v157, v153, s16
    v_perm_b32 v157, v157, v153, s17
    v_perm_b32 v153, v158, v154, s16
    v_perm_b32 v158, v158, v154, s17
    v_perm_b32 v154, v159, v155, s16
    v_perm_b32 v159, v159, v155, s17
    s_waitcnt vmcnt(18)
    v_perm_b32 v16, v84, v80, s16
    v_perm_b32 v17, v84, v80, s17
    v_perm_b32 v18, v85, v81, s16
    v_perm_b32 v19, v85, v81, s17
    v_perm_b32 v20, v86, v82, s16
    v_perm_b32 v21, v86, v82, s17
    v_perm_b32 v22, v87, v83, s16
    v_perm_b32 v23, v87, v83, s17
    v_dot2_f32_bf16 v8, v16, v30, v8
    v_dot2_f32_bf16 v9, v17, v30, v9
    v_dot2_f32_bf16 v10, v18, v30, v10
    v_dot2_f32_bf16 v11, v19, v30, v11
    v_dot2_f32_bf16 v12, v20, v30, v12
    v_dot2_f32_bf16 v13, v21, v30, v13
    v_dot2_f32_bf16 v14, v22, v30, v14
    v_dot2_f32_bf16 v15, v23, v30, v15
    s_add_u32 s12, s12, s21
    buffer_load_dwordx4 v[80:83], v3, s[48:51], s12 offen offset:0 nt
    buffer_load_dwordx4 v[84:87], v3, s[48:51], s12 offen offset:1024 nt
    buffer_load_dwordx4 v[176:179], v54, s[60:63], s19 offen offset:0
    s_waitcnt vmcnt(18)
    v_perm_b32 v16, v92, v88, s16
    v_perm_b32 v17, v92, v88, s17
    v_perm_b32 v18, v93, v89, s16
    v_perm_b32 v19, v93, v89, s17
    v_perm_b32 v20, v94, v90, s16
    v_perm_b32 v21, v94, v90, s17
    v_perm_b32 v22, v95, v91, s16
    v_perm_b32 v23, v95, v91, s17
    v_dot2_f32_bf16 v8, v16, v31, v8
    v_dot2_f32_bf16 v9, v17, v31, v9
    v_dot2_f32_bf16 v10, v18, v31, v10
    v_dot2_f32_bf16 v11, v19, v31, v11
    v_dot2_f32_bf16 v12, v20, v31, v12
    v_dot2_f32_bf16 v13, v21, v31, v13
    v_dot2_f32_bf16 v14, v22, v31, v14
    v_dot2_f32_bf16 v15, v23, v31, v15
    buffer_load_dwordx4 v[88:91], v3, s[48:51], s12 offen offset:2048 nt
    buffer_load_dwordx4 v[92:95], v3, s[48:51], s12 offen offset:3072 nt
    ds_read_b128 v[28:31], v57 offset:25712
    s_waitcnt vmcnt(18) lgkmcnt(1)
    v_perm_b32 v16, v100, v96, s16
    v_perm_b32 v17, v100, v96, s17
    v_perm_b32 v18, v101, v97, s16
    v_perm_b32 v19, v101, v97, s17
    v_perm_b32 v20, v102, v98, s16
    v_perm_b32 v21, v102, v98, s17
    v_perm_b32 v22, v103, v99, s16
    v_perm_b32 v23, v103, v99, s17
    v_dot2_f32_bf16 v8, v16, v24, v8
    v_dot2_f32_bf16 v9, v17, v24, v9
    v_dot2_f32_bf16 v10, v18, v24, v10
    v_dot2_f32_bf16 v11, v19, v24, v11
    v_dot2_f32_bf16 v12, v20, v24, v12
    v_dot2_f32_bf16 v13, v21, v24, v13
    v_dot2_f32_bf16 v14, v22, v24, v14
    v_dot2_f32_bf16 v15, v23, v24, v15
    s_add_u32 s9, s9, s21
    buffer_load_dwordx4 v[96:99], v3, s[48:51], s9 offen offset:0 nt
    buffer_load_dwordx4 v[180:183], v54, s[60:63], s19 offen offset:896
    buffer_load_dwordx4 v[100:103], v3, s[48:51], s9 offen offset:1024 nt
    s_waitcnt vmcnt(18)
    v_perm_b32 v16, v108, v104, s16
    v_perm_b32 v17, v108, v104, s17
    v_perm_b32 v18, v109, v105, s16
    v_perm_b32 v19, v109, v105, s17
    v_perm_b32 v20, v110, v106, s16
    v_perm_b32 v21, v110, v106, s17
    v_perm_b32 v22, v111, v107, s16
    v_perm_b32 v23, v111, v107, s17
    v_dot2_f32_bf16 v8, v16, v25, v8
    v_dot2_f32_bf16 v9, v17, v25, v9
    v_dot2_f32_bf16 v10, v18, v25, v10
    v_dot2_f32_bf16 v11, v19, v25, v11
    v_dot2_f32_bf16 v12, v20, v25, v12
    v_dot2_f32_bf16 v13, v21, v25, v13
    v_dot2_f32_bf16 v14, v22, v25, v14
    v_dot2_f32_bf16 v15, v23, v25, v15
    buffer_load_dwordx4 v[104:107], v3, s[48:51], s9 offen offset:2048 nt
    buffer_load_dwordx4 v[108:111], v3, s[48:51], s9 offen offset:3072 nt
    v_perm_b32 v155, v164, v160, s16
    v_perm_b32 v164, v164, v160, s17
    v_perm_b32 v160, v165, v161, s16
    v_perm_b32 v165, v165, v161, s17
    v_perm_b32 v161, v166, v162, s16
    v_perm_b32 v166, v166, v162, s17
    v_perm_b32 v162, v167, v163, s16
    v_perm_b32 v167, v167, v163, s17
    s_waitcnt vmcnt(18)
    v_perm_b32 v16, v116, v112, s16
    v_perm_b32 v17, v116, v112, s17
    v_perm_b32 v18, v117, v113, s16
    v_perm_b32 v19, v117, v113, s17
    v_perm_b32 v20, v118, v114, s16
    v_perm_b32 v21, v118, v114, s17
    v_perm_b32 v22, v119, v115, s16
    v_perm_b32 v23, v119, v115, s17
    v_dot2_f32_bf16 v8, v16, v26, v8
    v_dot2_f32_bf16 v9, v17, v26, v9
    v_dot2_f32_bf16 v10, v18, v26, v10
    v_dot2_f32_bf16 v11, v19, v26, v11
    v_dot2_f32_bf16 v12, v20, v26, v12
    v_dot2_f32_bf16 v13, v21, v26, v13
    v_dot2_f32_bf16 v14, v22, v26, v14
    v_dot2_f32_bf16 v15, v23, v26, v15
    s_add_u32 s10, s10, s21
    buffer_load_dwordx4 v[112:115], v3, s[48:51], s10 offen offset:0 nt
    buffer_load_dwordx4 v[184:187], v54, s[60:63], s19 offen offset:1792
    buffer_load_dwordx4 v[116:119], v3, s[48:51], s10 offen offset:1024 nt
    s_waitcnt vmcnt(18)
    v_perm_b32 v16, v124, v120, s16
    v_perm_b32 v17, v124, v120, s17
    v_perm_b32 v18, v125, v121, s16
    v_perm_b32 v19, v125, v121, s17
    v_perm_b32 v20, v126, v122, s16
    v_perm_b32 v21, v126, v122, s17
    v_perm_b32 v22, v127, v123, s16
    v_perm_b32 v23, v127, v123, s17
    v_dot2_f32_bf16 v8, v16, v27, v8
    v_dot2_f32_bf16 v9, v17, v27, v9
    v_dot2_f32_bf16 v10, v18, v27, v10
    v_dot2_f32_bf16 v11, v19, v27, v11
    v_dot2_f32_bf16 v12, v20, v27, v12
    v_dot2_f32_bf16 v13, v21, v27, v13
    v_dot2_f32_bf16 v14, v22, v27, v14
    v_dot2_f32_bf16 v15, v23, v27, v15
    buffer_load_dwordx4 v[120:123], v3, s[48:51], s10 offen offset:2048 nt
    buffer_load_dwordx4 v[124:127], v3, s[48:51], s10 offen offset:3072 nt
    ds_read_b128 v[24:27], v57 offset:25728
    s_waitcnt vmcnt(18) lgkmcnt(1)
    v_perm_b32 v16, v68, v64, s16
    v_perm_b32 v17, v68, v64, s17
    v_perm_b32 v18, v69, v65, s16
    v_perm_b32 v19, v69, v65, s17
    v_perm_b32 v20, v70, v66, s16
    v_perm_b32 v21, v70, v66, s17
    v_perm_b32 v22, v71, v67, s16
    v_perm_b32 v23, v71, v67, s17
    v_dot2_f32_bf16 v8, v16, v28, v8
    v_dot2_f32_bf16 v9, v17, v28, v9
    v_dot2_f32_bf16 v10, v18, v28, v10
    v_dot2_f32_bf16 v11, v19, v28, v11
    v_dot2_f32_bf16 v12, v20, v28, v12
    v_dot2_f32_bf16 v13, v21, v28, v13
    v_dot2_f32_bf16 v14, v22, v28, v14
    v_dot2_f32_bf16 v15, v23, v28, v15
    s_add_u32 s11, s11, s21
    buffer_load_dwordx4 v[64:67], v3, s[48:51], s11 offen offset:0 nt
    buffer_load_dwordx4 v[188:191], v54, s[60:63], s19 offen offset:2688
    s_add_u32 s19, s19, s20
    buffer_load_dwordx4 v[68:71], v3, s[48:51], s11 offen offset:1024 nt
    s_waitcnt vmcnt(18)
    v_perm_b32 v16, v76, v72, s16
    v_perm_b32 v17, v76, v72, s17
    v_perm_b32 v18, v77, v73, s16
    v_perm_b32 v19, v77, v73, s17
    v_perm_b32 v20, v78, v74, s16
    v_perm_b32 v21, v78, v74, s17
    v_perm_b32 v22, v79, v75, s16
    v_perm_b32 v23, v79, v75, s17
    v_dot2_f32_bf16 v8, v16, v29, v8
    v_dot2_f32_bf16 v9, v17, v29, v9
    v_dot2_f32_bf16 v10, v18, v29, v10
    v_dot2_f32_bf16 v11, v19, v29, v11
    v_dot2_f32_bf16 v12, v20, v29, v12
    v_dot2_f32_bf16 v13, v21, v29, v13
    v_dot2_f32_bf16 v14, v22, v29, v14
    v_dot2_f32_bf16 v15, v23, v29, v15
    buffer_load_dwordx4 v[72:75], v3, s[48:51], s11 offen offset:2048 nt
    buffer_load_dwordx4 v[76:79], v3, s[48:51], s11 offen offset:3072 nt
    v_perm_b32 v163, v172, v168, s16
    v_perm_b32 v172, v172, v168, s17
    v_perm_b32 v168, v173, v169, s16
    v_perm_b32 v173, v173, v169, s17
    v_perm_b32 v169, v174, v170, s16
    v_perm_b32 v174, v174, v170, s17
    v_perm_b32 v170, v175, v171, s16
    v_perm_b32 v175, v175, v171, s17
    s_waitcnt vmcnt(18)
    v_perm_b32 v16, v84, v80, s16
    v_perm_b32 v17, v84, v80, s17
    v_perm_b32 v18, v85, v81, s16
    v_perm_b32 v19, v85, v81, s17
    v_perm_b32 v20, v86, v82, s16
    v_perm_b32 v21, v86, v82, s17
    v_perm_b32 v22, v87, v83, s16
    v_perm_b32 v23, v87, v83, s17
    v_dot2_f32_bf16 v8, v16, v30, v8
    v_dot2_f32_bf16 v9, v17, v30, v9
    v_dot2_f32_bf16 v10, v18, v30, v10
    v_dot2_f32_bf16 v11, v19, v30, v11
    v_dot2_f32_bf16 v12, v20, v30, v12
    v_dot2_f32_bf16 v13, v21, v30, v13
    v_dot2_f32_bf16 v14, v22, v30, v14
    v_dot2_f32_bf16 v15, v23, v30, v15
    s_add_u32 s12, s12, s21
    buffer_load_dwordx4 v[80:83], v3, s[48:51], s12 offen offset:0 nt
    buffer_load_dwordx4 v[192:195], v54, s[60:63], s19 offen offset:0
    buffer_load_dwordx4 v[84:87], v3, s[48:51], s12 offen offset:1024 nt
    s_waitcnt vmcnt(18)
    v_perm_b32 v16, v92, v88, s16
    v_perm_b32 v17, v92, v88, s17
    v_perm_b32 v18, v93, v89, s16
    v_perm_b32 v19, v93, v89, s17
    v_perm_b32 v20, v94, v90, s16
    v_perm_b32 v21, v94, v90, s17
    v_perm_b32 v22, v95, v91, s16
    v_perm_b32 v23, v95, v91, s17
    v_dot2_f32_bf16 v8, v16, v31, v8
    v_dot2_f32_bf16 v9, v17, v31, v9
    v_dot2_f32_bf16 v10, v18, v31, v10
    v_dot2_f32_bf16 v11, v19, v31, v11
    v_dot2_f32_bf16 v12, v20, v31, v12
    v_dot2_f32_bf16 v13, v21, v31, v13
    v_dot2_f32_bf16 v14, v22, v31, v14
    v_dot2_f32_bf16 v15, v23, v31, v15
    buffer_load_dwordx4 v[88:91], v3, s[48:51], s12 offen offset:2048 nt
    buffer_load_dwordx4 v[92:95], v3, s[48:51], s12 offen offset:3072 nt
    buffer_load_dwordx4 v[196:199], v54, s[60:63], s19 offen offset:896
    ds_read_b128 v[28:31], v57 offset:25744
    s_waitcnt vmcnt(18) lgkmcnt(1)
    v_perm_b32 v16, v100, v96, s16
    v_perm_b32 v17, v100, v96, s17
    v_perm_b32 v18, v101, v97, s16
    v_perm_b32 v19, v101, v97, s17
    v_perm_b32 v20, v102, v98, s16
    v_perm_b32 v21, v102, v98, s17
    v_perm_b32 v22, v103, v99, s16
    v_perm_b32 v23, v103, v99, s17
    v_dot2_f32_bf16 v8, v16, v24, v8
    v_dot2_f32_bf16 v9, v17, v24, v9
    v_dot2_f32_bf16 v10, v18, v24, v10
    v_dot2_f32_bf16 v11, v19, v24, v11
    v_dot2_f32_bf16 v12, v20, v24, v12
    v_dot2_f32_bf16 v13, v21, v24, v13
    v_dot2_f32_bf16 v14, v22, v24, v14
    v_dot2_f32_bf16 v15, v23, v24, v15
    s_add_u32 s9, s9, s21
    buffer_load_dwordx4 v[96:99], v3, s[48:51], s9 offen offset:0 nt
    buffer_load_dwordx4 v[100:103], v3, s[48:51], s9 offen offset:1024 nt
    v_perm_b32 v171, v180, v176, s16
    v_perm_b32 v180, v180, v176, s17
    v_perm_b32 v176, v181, v177, s16
    v_perm_b32 v181, v181, v177, s17
    v_perm_b32 v177, v182, v178, s16
    v_perm_b32 v182, v182, v178, s17
    v_perm_b32 v178, v183, v179, s16
    v_perm_b32 v183, v183, v179, s17
    s_waitcnt vmcnt(18)
    v_perm_b32 v16, v108, v104, s16
    v_perm_b32 v17, v108, v104, s17
    v_perm_b32 v18, v109, v105, s16
    v_perm_b32 v19, v109, v105, s17
    v_perm_b32 v20, v110, v106, s16
    v_perm_b32 v21, v110, v106, s17
    v_perm_b32 v22, v111, v107, s16
    v_perm_b32 v23, v111, v107, s17
    v_dot2_f32_bf16 v8, v16, v25, v8
    v_dot2_f32_bf16 v9, v17, v25, v9
    v_dot2_f32_bf16 v10, v18, v25, v10
    v_dot2_f32_bf16 v11, v19, v25, v11
    v_dot2_f32_bf16 v12, v20, v25, v12
    v_dot2_f32_bf16 v13, v21, v25, v13
    v_dot2_f32_bf16 v14, v22, v25, v14
    v_dot2_f32_bf16 v15, v23, v25, v15
    buffer_load_dwordx4 v[104:107], v3, s[48:51], s9 offen offset:2048 nt
    buffer_load_dwordx4 v[108:111], v3, s[48:51], s9 offen offset:3072 nt
    buffer_load_dwordx4 v[200:203], v54, s[60:63], s19 offen offset:1792
    s_waitcnt vmcnt(18)
    v_perm_b32 v16, v116, v112, s16
    v_perm_b32 v17, v116, v112, s17
    v_perm_b32 v18, v117, v113, s16
    v_perm_b32 v19, v117, v113, s17
    v_perm_b32 v20, v118, v114, s16
    v_perm_b32 v21, v118, v114, s17
    v_perm_b32 v22, v119, v115, s16
    v_perm_b32 v23, v119, v115, s17
    v_dot2_f32_bf16 v8, v16, v26, v8
    v_dot2_f32_bf16 v9, v17, v26, v9
    v_dot2_f32_bf16 v10, v18, v26, v10
    v_dot2_f32_bf16 v11, v19, v26, v11
    v_dot2_f32_bf16 v12, v20, v26, v12
    v_dot2_f32_bf16 v13, v21, v26, v13
    v_dot2_f32_bf16 v14, v22, v26, v14
    v_dot2_f32_bf16 v15, v23, v26, v15
    s_add_u32 s10, s10, s21
    buffer_load_dwordx4 v[112:115], v3, s[48:51], s10 offen offset:0 nt
    buffer_load_dwordx4 v[116:119], v3, s[48:51], s10 offen offset:1024 nt
    s_waitcnt vmcnt(18)
    v_perm_b32 v16, v124, v120, s16
    v_perm_b32 v17, v124, v120, s17
    v_perm_b32 v18, v125, v121, s16
    v_perm_b32 v19, v125, v121, s17
    v_perm_b32 v20, v126, v122, s16
    v_perm_b32 v21, v126, v122, s17
    v_perm_b32 v22, v127, v123, s16
    v_perm_b32 v23, v127, v123, s17
    v_dot2_f32_bf16 v8, v16, v27, v8
    v_dot2_f32_bf16 v9, v17, v27, v9
    v_dot2_f32_bf16 v10, v18, v27, v10
    v_dot2_f32_bf16 v11, v19, v27, v11
    v_dot2_f32_bf16 v12, v20, v27, v12
    v_dot2_f32_bf16 v13, v21, v27, v13
    v_dot2_f32_bf16 v14, v22, v27, v14
    v_dot2_f32_bf16 v15, v23, v27, v15
    buffer_load_dwordx4 v[120:123], v3, s[48:51], s10 offen offset:2048 nt
    buffer_load_dwordx4 v[124:127], v3, s[48:51], s10 offen offset:3072 nt
    buffer_load_dwordx4 v[204:207], v54, s[60:63], s19 offen offset:2688
    s_add_u32 s19, s19, s20
    ds_read_b128 v[24:27], v57 offset:25760
    s_waitcnt vmcnt(18) lgkmcnt(1)
    v_perm_b32 v16, v68, v64, s16
    v_perm_b32 v17, v68, v64, s17
    v_perm_b32 v18, v69, v65, s16
    v_perm_b32 v19, v69, v65, s17
    v_perm_b32 v20, v70, v66, s16
    v_perm_b32 v21, v70, v66, s17
    v_perm_b32 v22, v71, v67, s16
    v_perm_b32 v23, v71, v67, s17
    v_dot2_f32_bf16 v8, v16, v28, v8
    v_dot2_f32_bf16 v9, v17, v28, v9
    v_dot2_f32_bf16 v10, v18, v28, v10
    v_dot2_f32_bf16 v11, v19, v28, v11
    v_dot2_f32_bf16 v12, v20, v28, v12
    v_dot2_f32_bf16 v13, v21, v28, v13
    v_dot2_f32_bf16 v14, v22, v28, v14
    v_dot2_f32_bf16 v15, v23, v28, v15
    s_add_u32 s11, s11, s21
    buffer_load_dwordx4 v[64:67], v3, s[48:51], s11 offen offset:0 nt
    buffer_load_dwordx4 v[68:71], v3, s[48:51], s11 offen offset:1024 nt
    v_perm_b32 v179, v188, v184, s16
    v_perm_b32 v188, v188, v184, s17
    v_perm_b32 v184, v189, v185, s16
    v_perm_b32 v189, v189, v185, s17
    v_perm_b32 v185, v190, v186, s16
    v_perm_b32 v190, v190, v186, s17
    v_perm_b32 v186, v191, v187, s16
    v_perm_b32 v191, v191, v187, s17
    s_waitcnt vmcnt(18)
    v_perm_b32 v16, v76, v72, s16
    v_perm_b32 v17, v76, v72, s17
    v_perm_b32 v18, v77, v73, s16
    v_perm_b32 v19, v77, v73, s17
    v_perm_b32 v20, v78, v74, s16
    v_perm_b32 v21, v78, v74, s17
    v_perm_b32 v22, v79, v75, s16
    v_perm_b32 v23, v79, v75, s17
    v_dot2_f32_bf16 v8, v16, v29, v8
    v_dot2_f32_bf16 v9, v17, v29, v9
    v_dot2_f32_bf16 v10, v18, v29, v10
    v_dot2_f32_bf16 v11, v19, v29, v11
    v_dot2_f32_bf16 v12, v20, v29, v12
    v_dot2_f32_bf16 v13, v21, v29, v13
    v_dot2_f32_bf16 v14, v22, v29, v14
    v_dot2_f32_bf16 v15, v23, v29, v15
    buffer_load_dwordx4 v[72:75], v3, s[48:51], s11 offen offset:2048 nt
    buffer_load_dwordx4 v[76:79], v3, s[48:51], s11 offen offset:3072 nt
    buffer_load_dwordx4 v[208:211], v54, s[60:63], s19 offen offset:0
    s_waitcnt vmcnt(18)
    v_perm_b32 v16, v84, v80, s16
    v_perm_b32 v17, v84, v80, s17
    v_perm_b32 v18, v85, v81, s16
    v_perm_b32 v19, v85, v81, s17
    v_perm_b32 v20, v86, v82, s16
    v_perm_b32 v21, v86, v82, s17
    v_perm_b32 v22, v87, v83, s16
    v_perm_b32 v23, v87, v83, s17
    v_dot2_f32_bf16 v8, v16, v30, v8
    v_dot2_f32_bf16 v9, v17, v30, v9
    v_dot2_f32_bf16 v10, v18, v30, v10
    v_dot2_f32_bf16 v11, v19, v30, v11
    v_dot2_f32_bf16 v12, v20, v30, v12
    v_dot2_f32_bf16 v13, v21, v30, v13
    v_dot2_f32_bf16 v14, v22, v30, v14
    v_dot2_f32_bf16 v15, v23, v30, v15
    s_add_u32 s12, s12, s21
    buffer_load_dwordx4 v[80:83], v3, s[48:51], s12 offen offset:0 nt
    buffer_load_dwordx4 v[84:87], v3, s[48:51], s12 offen offset:1024 nt
    s_waitcnt vmcnt(18)
    v_perm_b32 v16, v92, v88, s16
    v_perm_b32 v17, v92, v88, s17
    v_perm_b32 v18, v93, v89, s16
    v_perm_b32 v19, v93, v89, s17
    v_perm_b32 v20, v94, v90, s16
    v_perm_b32 v21, v94, v90, s17
    v_perm_b32 v22, v95, v91, s16
    v_perm_b32 v23, v95, v91, s17
    v_dot2_f32_bf16 v8, v16, v31, v8
    v_dot2_f32_bf16 v9, v17, v31, v9
    v_dot2_f32_bf16 v10, v18, v31, v10
    v_dot2_f32_bf16 v11, v19, v31, v11
    v_dot2_f32_bf16 v12, v20, v31, v12
    v_dot2_f32_bf16 v13, v21, v31, v13
    v_dot2_f32_bf16 v14, v22, v31, v14
    v_dot2_f32_bf16 v15, v23, v31, v15
    buffer_load_dwordx4 v[88:91], v3, s[48:51], s12 offen offset:2048 nt
    buffer_load_dwordx4 v[212:215], v54, s[60:63], s19 offen offset:896
    buffer_load_dwordx4 v[92:95], v3, s[48:51], s12 offen offset:3072 nt
    ds_read_b128 v[28:31], v57 offset:25776
    s_waitcnt vmcnt(18) lgkmcnt(1)
    v_perm_b32 v16, v100, v96, s16
    v_perm_b32 v17, v100, v96, s17
    v_perm_b32 v18, v101, v97, s16
    v_perm_b32 v19, v101, v97, s17
    v_perm_b32 v20, v102, v98, s16
    v_perm_b32 v21, v102, v98, s17
    v_perm_b32 v22, v103, v99, s16
    v_perm_b32 v23, v103, v99, s17
    v_dot2_f32_bf16 v8, v16, v24, v8
    v_dot2_f32_bf16 v9, v17, v24, v9
    v_dot2_f32_bf16 v10, v18, v24, v10
    v_dot2_f32_bf16 v11, v19, v24, v11
    v_dot2_f32_bf16 v12, v20, v24, v12
    v_dot2_f32_bf16 v13, v21, v24, v13
    v_dot2_f32_bf16 v14, v22, v24, v14
    v_dot2_f32_bf16 v15, v23, v24, v15
    s_add_u32 s9, s9, s21
    buffer_load_dwordx4 v[96:99], v3, s[48:51], s9 offen offset:0 nt
    buffer_load_dwordx4 v[100:103], v3, s[48:51], s9 offen offset:1024 nt
    v_perm_b32 v187, v196, v192, s16
    v_perm_b32 v196, v196, v192, s17
    v_perm_b32 v192, v197, v193, s16
    v_perm_b32 v197, v197, v193, s17
    v_perm_b32 v193, v198, v194, s16
    v_perm_b32 v198, v198, v194, s17
    v_perm_b32 v194, v199, v195, s16
    v_perm_b32 v199, v199, v195, s17
    s_waitcnt vmcnt(18)
    v_perm_b32 v16, v108, v104, s16
    v_perm_b32 v17, v108, v104, s17
    v_perm_b32 v18, v109, v105, s16
    v_perm_b32 v19, v109, v105, s17
    v_perm_b32 v20, v110, v106, s16
    v_perm_b32 v21, v110, v106, s17
    v_perm_b32 v22, v111, v107, s16
    v_perm_b32 v23, v111, v107, s17
    v_dot2_f32_bf16 v8, v16, v25, v8
    v_dot2_f32_bf16 v9, v17, v25, v9
    v_dot2_f32_bf16 v10, v18, v25, v10
    v_dot2_f32_bf16 v11, v19, v25, v11
    v_dot2_f32_bf16 v12, v20, v25, v12
    v_dot2_f32_bf16 v13, v21, v25, v13
    v_dot2_f32_bf16 v14, v22, v25, v14
    v_dot2_f32_bf16 v15, v23, v25, v15
    buffer_load_dwordx4 v[104:107], v3, s[48:51], s9 offen offset:2048 nt
    buffer_load_dwordx4 v[216:219], v54, s[60:63], s19 offen offset:1792
    buffer_load_dwordx4 v[108:111], v3, s[48:51], s9 offen offset:3072 nt
    s_waitcnt vmcnt(18)
    v_perm_b32 v16, v116, v112, s16
    v_perm_b32 v17, v116, v112, s17
    v_perm_b32 v18, v117, v113, s16
    v_perm_b32 v19, v117, v113, s17
    v_perm_b32 v20, v118, v114, s16
    v_perm_b32 v21, v118, v114, s17
    v_perm_b32 v22, v119, v115, s16
    v_perm_b32 v23, v119, v115, s17
    v_dot2_f32_bf16 v8, v16, v26, v8
    v_dot2_f32_bf16 v9, v17, v26, v9
    v_dot2_f32_bf16 v10, v18, v26, v10
    v_dot2_f32_bf16 v11, v19, v26, v11
    v_dot2_f32_bf16 v12, v20, v26, v12
    v_dot2_f32_bf16 v13, v21, v26, v13
    v_dot2_f32_bf16 v14, v22, v26, v14
    v_dot2_f32_bf16 v15, v23, v26, v15
    s_add_u32 s10, s10, s21
    buffer_load_dwordx4 v[112:115], v3, s[48:51], s10 offen offset:0 nt
    buffer_load_dwordx4 v[116:119], v3, s[48:51], s10 offen offset:1024 nt
    s_waitcnt vmcnt(18)
    v_perm_b32 v16, v124, v120, s16
    v_perm_b32 v17, v124, v120, s17
    v_perm_b32 v18, v125, v121, s16
    v_perm_b32 v19, v125, v121, s17
    v_perm_b32 v20, v126, v122, s16
    v_perm_b32 v21, v126, v122, s17
    v_perm_b32 v22, v127, v123, s16
    v_perm_b32 v23, v127, v123, s17
    v_dot2_f32_bf16 v8, v16, v27, v8
    v_dot2_f32_bf16 v9, v17, v27, v9
    v_dot2_f32_bf16 v10, v18, v27, v10
    v_dot2_f32_bf16 v11, v19, v27, v11
    v_dot2_f32_bf16 v12, v20, v27, v12
    v_dot2_f32_bf16 v13, v21, v27, v13
    v_dot2_f32_bf16 v14, v22, v27, v14
    v_dot2_f32_bf16 v15, v23, v27, v15
    buffer_load_dwordx4 v[120:123], v3, s[48:51], s10 offen offset:2048 nt
    buffer_load_dwordx4 v[220:223], v54, s[60:63], s19 offen offset:2688
    s_add_u32 s19, s19, s20
    buffer_load_dwordx4 v[124:127], v3, s[48:51], s10 offen offset:3072 nt
    ds_read_b128 v[24:27], v57 offset:25792
    s_waitcnt vmcnt(18) lgkmcnt(1)
    v_perm_b32 v16, v68, v64, s16
    v_perm_b32 v17, v68, v64, s17
    v_perm_b32 v18, v69, v65, s16
    v_perm_b32 v19, v69, v65, s17
    v_perm_b32 v20, v70, v66, s16
    v_perm_b32 v21, v70, v66, s17
    v_perm_b32 v22, v71, v67, s16
    v_perm_b32 v23, v71, v67, s17
    v_dot2_f32_bf16 v8, v16, v28, v8
    v_dot2_f32_bf16 v9, v17, v28, v9
    v_dot2_f32_bf16 v10, v18, v28, v10
    v_dot2_f32_bf16 v11, v19, v28, v11
    v_dot2_f32_bf16 v12, v20, v28, v12
    v_dot2_f32_bf16 v13, v21, v28, v13
    v_dot2_f32_bf16 v14, v22, v28, v14
    v_dot2_f32_bf16 v15, v23, v28, v15
    s_add_u32 s11, s11, s21
    buffer_load_dwordx4 v[64:67], v3, s[48:51], s11 offen offset:0 nt
    buffer_load_dwordx4 v[68:71], v3, s[48:51], s11 offen offset:1024 nt
    v_perm_b32 v195, v204, v200, s16
    v_perm_b32 v204, v204, v200, s17
    v_perm_b32 v200, v205, v201, s16
    v_perm_b32 v205, v205, v201, s17
    v_perm_b32 v201, v206, v202, s16
    v_perm_b32 v206, v206, v202, s17
    v_perm_b32 v202, v207, v203, s16
    v_perm_b32 v207, v207, v203, s17
    s_waitcnt vmcnt(18)
    v_perm_b32 v16, v76, v72, s16
    v_perm_b32 v17, v76, v72, s17
    v_perm_b32 v18, v77, v73, s16
    v_perm_b32 v19, v77, v73, s17
    v_perm_b32 v20, v78, v74, s16
    v_perm_b32 v21, v78, v74, s17
    v_perm_b32 v22, v79, v75, s16
    v_perm_b32 v23, v79, v75, s17
    v_dot2_f32_bf16 v8, v16, v29, v8
    v_dot2_f32_bf16 v9, v17, v29, v9
    v_dot2_f32_bf16 v10, v18, v29, v10
    v_dot2_f32_bf16 v11, v19, v29, v11
    v_dot2_f32_bf16 v12, v20, v29, v12
    v_dot2_f32_bf16 v13, v21, v29, v13
    v_dot2_f32_bf16 v14, v22, v29, v14
    v_dot2_f32_bf16 v15, v23, v29, v15
    buffer_load_dwordx4 v[72:75], v3, s[48:51], s11 offen offset:2048 nt
    buffer_load_dwordx4 v[224:227], v54, s[60:63], s19 offen offset:0
    buffer_load_dwordx4 v[76:79], v3, s[48:51], s11 offen offset:3072 nt
    s_waitcnt vmcnt(18)
    v_perm_b32 v16, v84, v80, s16
    v_perm_b32 v17, v84, v80, s17
    v_perm_b32 v18, v85, v81, s16
    v_perm_b32 v19, v85, v81, s17
    v_perm_b32 v20, v86, v82, s16
    v_perm_b32 v21, v86, v82, s17
    v_perm_b32 v22, v87, v83, s16
    v_perm_b32 v23, v87, v83, s17
    v_dot2_f32_bf16 v8, v16, v30, v8
    v_dot2_f32_bf16 v9, v17, v30, v9
    v_dot2_f32_bf16 v10, v18, v30, v10
    v_dot2_f32_bf16 v11, v19, v30, v11
    v_dot2_f32_bf16 v12, v20, v30, v12
    v_dot2_f32_bf16 v13, v21, v30, v13
    v_dot2_f32_bf16 v14, v22, v30, v14
    v_dot2_f32_bf16 v15, v23, v30, v15
    s_add_u32 s12, s12, s21
    buffer_load_dwordx4 v[80:83], v3, s[48:51], s12 offen offset:0 nt
    buffer_load_dwordx4 v[84:87], v3, s[48:51], s12 offen offset:1024 nt
    buffer_load_dwordx4 v[228:231], v54, s[60:63], s19 offen offset:896
    s_waitcnt vmcnt(18)
    v_perm_b32 v16, v92, v88, s16
    v_perm_b32 v17, v92, v88, s17
    v_perm_b32 v18, v93, v89, s16
    v_perm_b32 v19, v93, v89, s17
    v_perm_b32 v20, v94, v90, s16
    v_perm_b32 v21, v94, v90, s17
    v_perm_b32 v22, v95, v91, s16
    v_perm_b32 v23, v95, v91, s17
    v_dot2_f32_bf16 v8, v16, v31, v8
    v_dot2_f32_bf16 v9, v17, v31, v9
    v_dot2_f32_bf16 v10, v18, v31, v10
    v_dot2_f32_bf16 v11, v19, v31, v11
    v_dot2_f32_bf16 v12, v20, v31, v12
    v_dot2_f32_bf16 v13, v21, v31, v13
    v_dot2_f32_bf16 v14, v22, v31, v14
    v_dot2_f32_bf16 v15, v23, v31, v15
    buffer_load_dwordx4 v[88:91], v3, s[48:51], s12 offen offset:2048 nt
    buffer_load_dwordx4 v[92:95], v3, s[48:51], s12 offen offset:3072 nt
    v_perm_b32 v203, v212, v208, s16
    v_perm_b32 v212, v212, v208, s17
    v_perm_b32 v208, v213, v209, s16
    v_perm_b32 v213, v213, v209, s17
    v_perm_b32 v209, v214, v210, s16
    v_perm_b32 v214, v214, v210, s17
    v_perm_b32 v210, v215, v211, s16
    v_perm_b32 v215, v215, v211, s17
    ds_read_b128 v[28:31], v57 offset:25808
    s_waitcnt vmcnt(18) lgkmcnt(1)
    v_perm_b32 v16, v100, v96, s16
    v_perm_b32 v17, v100, v96, s17
    v_perm_b32 v18, v101, v97, s16
    v_perm_b32 v19, v101, v97, s17
    v_perm_b32 v20, v102, v98, s16
    v_perm_b32 v21, v102, v98, s17
    v_perm_b32 v22, v103, v99, s16
    v_perm_b32 v23, v103, v99, s17
    v_dot2_f32_bf16 v8, v16, v24, v8
    v_dot2_f32_bf16 v9, v17, v24, v9
    v_dot2_f32_bf16 v10, v18, v24, v10
    v_dot2_f32_bf16 v11, v19, v24, v11
    v_dot2_f32_bf16 v12, v20, v24, v12
    v_dot2_f32_bf16 v13, v21, v24, v13
    v_dot2_f32_bf16 v14, v22, v24, v14
    v_dot2_f32_bf16 v15, v23, v24, v15
    s_add_u32 s9, s9, s21
    buffer_load_dwordx4 v[96:99], v3, s[48:51], s9 offen offset:0 nt
    buffer_load_dwordx4 v[100:103], v3, s[48:51], s9 offen offset:1024 nt
    buffer_load_dwordx4 v[232:235], v54, s[60:63], s19 offen offset:1792
    s_waitcnt vmcnt(18)
    v_perm_b32 v16, v108, v104, s16
    v_perm_b32 v17, v108, v104, s17
    v_perm_b32 v18, v109, v105, s16
    v_perm_b32 v19, v109, v105, s17
    v_perm_b32 v20, v110, v106, s16
    v_perm_b32 v21, v110, v106, s17
    v_perm_b32 v22, v111, v107, s16
    v_perm_b32 v23, v111, v107, s17
    v_dot2_f32_bf16 v8, v16, v25, v8
    v_dot2_f32_bf16 v9, v17, v25, v9
    v_dot2_f32_bf16 v10, v18, v25, v10
    v_dot2_f32_bf16 v11, v19, v25, v11
    v_dot2_f32_bf16 v12, v20, v25, v12
    v_dot2_f32_bf16 v13, v21, v25, v13
    v_dot2_f32_bf16 v14, v22, v25, v14
    v_dot2_f32_bf16 v15, v23, v25, v15
    buffer_load_dwordx4 v[104:107], v3, s[48:51], s9 offen offset:2048 nt
    buffer_load_dwordx4 v[108:111], v3, s[48:51], s9 offen offset:3072 nt
    s_waitcnt vmcnt(18)
    v_perm_b32 v16, v116, v112, s16
    v_perm_b32 v17, v116, v112, s17
    v_perm_b32 v18, v117, v113, s16
    v_perm_b32 v19, v117, v113, s17
    v_perm_b32 v20, v118, v114, s16
    v_perm_b32 v21, v118, v114, s17
    v_perm_b32 v22, v119, v115, s16
    v_perm_b32 v23, v119, v115, s17
    v_dot2_f32_bf16 v8, v16, v26, v8
    v_dot2_f32_bf16 v9, v17, v26, v9
    v_dot2_f32_bf16 v10, v18, v26, v10
    v_dot2_f32_bf16 v11, v19, v26, v11
    v_dot2_f32_bf16 v12, v20, v26, v12
    v_dot2_f32_bf16 v13, v21, v26, v13
    v_dot2_f32_bf16 v14, v22, v26, v14
    v_dot2_f32_bf16 v15, v23, v26, v15
    s_add_u32 s10, s10, s21
    buffer_load_dwordx4 v[112:115], v3, s[48:51], s10 offen offset:0 nt
    buffer_load_dwordx4 v[116:119], v3, s[48:51], s10 offen offset:1024 nt
    buffer_load_dwordx4 v[236:239], v54, s[60:63], s19 offen offset:2688
    s_add_u32 s19, s19, s20
    s_waitcnt vmcnt(18)
    v_perm_b32 v16, v124, v120, s16
    v_perm_b32 v17, v124, v120, s17
    v_perm_b32 v18, v125, v121, s16
    v_perm_b32 v19, v125, v121, s17
    v_perm_b32 v20, v126, v122, s16
    v_perm_b32 v21, v126, v122, s17
    v_perm_b32 v22, v127, v123, s16
    v_perm_b32 v23, v127, v123, s17
    v_dot2_f32_bf16 v8, v16, v27, v8
    v_dot2_f32_bf16 v9, v17, v27, v9
    v_dot2_f32_bf16 v10, v18, v27, v10
    v_dot2_f32_bf16 v11, v19, v27, v11
    v_dot2_f32_bf16 v12, v20, v27, v12
    v_dot2_f32_bf16 v13, v21, v27, v13
    v_dot2_f32_bf16 v14, v22, v27, v14
    v_dot2_f32_bf16 v15, v23, v27, v15
    buffer_load_dwordx4 v[120:123], v3, s[48:51], s10 offen offset:2048 nt
    buffer_load_dwordx4 v[124:127], v3, s[48:51], s10 offen offset:3072 nt
    v_perm_b32 v211, v220, v216, s16
    v_perm_b32 v220, v220, v216, s17
    v_perm_b32 v216, v221, v217, s16
    v_perm_b32 v221, v221, v217, s17
    v_perm_b32 v217, v222, v218, s16
    v_perm_b32 v222, v222, v218, s17
    v_perm_b32 v218, v223, v219, s16
    v_perm_b32 v223, v223, v219, s17
    ds_read_b128 v[24:27], v57 offset:25824
    s_waitcnt vmcnt(18) lgkmcnt(1)
    v_perm_b32 v16, v68, v64, s16
    v_perm_b32 v17, v68, v64, s17
    v_perm_b32 v18, v69, v65, s16
    v_perm_b32 v19, v69, v65, s17
    v_perm_b32 v20, v70, v66, s16
    v_perm_b32 v21, v70, v66, s17
    v_perm_b32 v22, v71, v67, s16
    v_perm_b32 v23, v71, v67, s17
    v_dot2_f32_bf16 v8, v16, v28, v8
    v_dot2_f32_bf16 v9, v17, v28, v9
    v_dot2_f32_bf16 v10, v18, v28, v10
    v_dot2_f32_bf16 v11, v19, v28, v11
    v_dot2_f32_bf16 v12, v20, v28, v12
    v_dot2_f32_bf16 v13, v21, v28, v13
    v_dot2_f32_bf16 v14, v22, v28, v14
    v_dot2_f32_bf16 v15, v23, v28, v15
    s_add_u32 s11, s11, s21
    buffer_load_dwordx4 v[64:67], v3, s[48:51], s11 offen offset:0 nt
    buffer_load_dwordx4 v[68:71], v3, s[48:51], s11 offen offset:1024 nt
    buffer_load_dwordx4 v[240:243], v54, s[60:63], s19 offen offset:0
    s_waitcnt vmcnt(18)
    v_perm_b32 v16, v76, v72, s16
    v_perm_b32 v17, v76, v72, s17
    v_perm_b32 v18, v77, v73, s16
    v_perm_b32 v19, v77, v73, s17
    v_perm_b32 v20, v78, v74, s16
    v_perm_b32 v21, v78, v74, s17
    v_perm_b32 v22, v79, v75, s16
    v_perm_b32 v23, v79, v75, s17
    v_dot2_f32_bf16 v8, v16, v29, v8
    v_dot2_f32_bf16 v9, v17, v29, v9
    v_dot2_f32_bf16 v10, v18, v29, v10
    v_dot2_f32_bf16 v11, v19, v29, v11
    v_dot2_f32_bf16 v12, v20, v29, v12
    v_dot2_f32_bf16 v13, v21, v29, v13
    v_dot2_f32_bf16 v14, v22, v29, v14
    v_dot2_f32_bf16 v15, v23, v29, v15
    buffer_load_dwordx4 v[72:75], v3, s[48:51], s11 offen offset:2048 nt
    buffer_load_dwordx4 v[76:79], v3, s[48:51], s11 offen offset:3072 nt
    s_waitcnt vmcnt(18)
    v_perm_b32 v16, v84, v80, s16
    v_perm_b32 v17, v84, v80, s17
    v_perm_b32 v18, v85, v81, s16
    v_perm_b32 v19, v85, v81, s17
    v_perm_b32 v20, v86, v82, s16
    v_perm_b32 v21, v86, v82, s17
    v_perm_b32 v22, v87, v83, s16
    v_perm_b32 v23, v87, v83, s17
    v_dot2_f32_bf16 v8, v16, v30, v8
    v_dot2_f32_bf16 v9, v17, v30, v9
    v_dot2_f32_bf16 v10, v18, v30, v10
    v_dot2_f32_bf16 v11, v19, v30, v11
    v_dot2_f32_bf16 v12, v20, v30, v12
    v_dot2_f32_bf16 v13, v21, v30, v13
    v_dot2_f32_bf16 v14, v22, v30, v14
    v_dot2_f32_bf16 v15, v23, v30, v15
    s_add_u32 s12, s12, s21
    buffer_load_dwordx4 v[80:83], v3, s[48:51], s12 offen offset:0 nt
    buffer_load_dwordx4 v[244:247], v54, s[60:63], s19 offen offset:896
    buffer_load_dwordx4 v[84:87], v3, s[48:51], s12 offen offset:1024 nt
    s_waitcnt vmcnt(18)
    v_perm_b32 v16, v92, v88, s16
    v_perm_b32 v17, v92, v88, s17
    v_perm_b32 v18, v93, v89, s16
    v_perm_b32 v19, v93, v89, s17
    v_perm_b32 v20, v94, v90, s16
    v_perm_b32 v21, v94, v90, s17
    v_perm_b32 v22, v95, v91, s16
    v_perm_b32 v23, v95, v91, s17
    v_dot2_f32_bf16 v8, v16, v31, v8
    v_dot2_f32_bf16 v9, v17, v31, v9
    v_dot2_f32_bf16 v10, v18, v31, v10
    v_dot2_f32_bf16 v11, v19, v31, v11
    v_dot2_f32_bf16 v12, v20, v31, v12
    v_dot2_f32_bf16 v13, v21, v31, v13
    v_dot2_f32_bf16 v14, v22, v31, v14
    v_dot2_f32_bf16 v15, v23, v31, v15
    buffer_load_dwordx4 v[88:91], v3, s[48:51], s12 offen offset:2048 nt
    buffer_load_dwordx4 v[92:95], v3, s[48:51], s12 offen offset:3072 nt
    v_perm_b32 v219, v228, v224, s16
    v_perm_b32 v228, v228, v224, s17
    v_perm_b32 v224, v229, v225, s16
    v_perm_b32 v229, v229, v225, s17
    v_perm_b32 v225, v230, v226, s16
    v_perm_b32 v230, v230, v226, s17
    v_perm_b32 v226, v231, v227, s16
    v_perm_b32 v231, v231, v227, s17
    ds_read_b128 v[28:31], v57 offset:25840
    s_waitcnt vmcnt(18) lgkmcnt(1)
    v_perm_b32 v16, v100, v96, s16
    v_perm_b32 v17, v100, v96, s17
    v_perm_b32 v18, v101, v97, s16
    v_perm_b32 v19, v101, v97, s17
    v_perm_b32 v20, v102, v98, s16
    v_perm_b32 v21, v102, v98, s17
    v_perm_b32 v22, v103, v99, s16
    v_perm_b32 v23, v103, v99, s17
    v_dot2_f32_bf16 v8, v16, v24, v8
    v_dot2_f32_bf16 v9, v17, v24, v9
    v_dot2_f32_bf16 v10, v18, v24, v10
    v_dot2_f32_bf16 v11, v19, v24, v11
    v_dot2_f32_bf16 v12, v20, v24, v12
    v_dot2_f32_bf16 v13, v21, v24, v13
    v_dot2_f32_bf16 v14, v22, v24, v14
    v_dot2_f32_bf16 v15, v23, v24, v15
    buffer_load_dwordx4 v[248:251], v54, s[60:63], s19 offen offset:1792
    s_waitcnt vmcnt(16)
    v_perm_b32 v16, v108, v104, s16
    v_perm_b32 v17, v108, v104, s17
    v_perm_b32 v18, v109, v105, s16
    v_perm_b32 v19, v109, v105, s17
    v_perm_b32 v20, v110, v106, s16
    v_perm_b32 v21, v110, v106, s17
    v_perm_b32 v22, v111, v107, s16
    v_perm_b32 v23, v111, v107, s17
    v_dot2_f32_bf16 v8, v16, v25, v8
    v_dot2_f32_bf16 v9, v17, v25, v9
    v_dot2_f32_bf16 v10, v18, v25, v10
    v_dot2_f32_bf16 v11, v19, v25, v11
    v_dot2_f32_bf16 v12, v20, v25, v12
    v_dot2_f32_bf16 v13, v21, v25, v13
    v_dot2_f32_bf16 v14, v22, v25, v14
    v_dot2_f32_bf16 v15, v23, v25, v15
    s_waitcnt vmcnt(14)
    v_perm_b32 v16, v116, v112, s16
    v_perm_b32 v17, v116, v112, s17
    v_perm_b32 v18, v117, v113, s16
    v_perm_b32 v19, v117, v113, s17
    v_perm_b32 v20, v118, v114, s16
    v_perm_b32 v21, v118, v114, s17
    v_perm_b32 v22, v119, v115, s16
    v_perm_b32 v23, v119, v115, s17
    v_dot2_f32_bf16 v8, v16, v26, v8
    v_dot2_f32_bf16 v9, v17, v26, v9
    v_dot2_f32_bf16 v10, v18, v26, v10
    v_dot2_f32_bf16 v11, v19, v26, v11
    v_dot2_f32_bf16 v12, v20, v26, v12
    v_dot2_f32_bf16 v13, v21, v26, v13
    v_dot2_f32_bf16 v14, v22, v26, v14
    v_dot2_f32_bf16 v15, v23, v26, v15
    buffer_load_dwordx4 v[252:255], v54, s[60:63], s19 offen offset:2688
    s_add_u32 s19, s19, s20
    s_waitcnt vmcnt(12)
    v_perm_b32 v16, v124, v120, s16
    v_perm_b32 v17, v124, v120, s17
    v_perm_b32 v18, v125, v121, s16
    v_perm_b32 v19, v125, v121, s17
    v_perm_b32 v20, v126, v122, s16
    v_perm_b32 v21, v126, v122, s17
    v_perm_b32 v22, v127, v123, s16
    v_perm_b32 v23, v127, v123, s17
    v_dot2_f32_bf16 v8, v16, v27, v8
    v_dot2_f32_bf16 v9, v17, v27, v9
    v_dot2_f32_bf16 v10, v18, v27, v10
    v_dot2_f32_bf16 v11, v19, v27, v11
    v_dot2_f32_bf16 v12, v20, v27, v12
    v_dot2_f32_bf16 v13, v21, v27, v13
    v_dot2_f32_bf16 v14, v22, v27, v14
    v_dot2_f32_bf16 v15, v23, v27, v15
    v_perm_b32 v227, v236, v232, s16
    v_perm_b32 v236, v236, v232, s17
    v_perm_b32 v232, v237, v233, s16
    v_perm_b32 v237, v237, v233, s17
    v_perm_b32 v233, v238, v234, s16
    v_perm_b32 v238, v238, v234, s17
    v_perm_b32 v234, v239, v235, s16
    v_perm_b32 v239, v239, v235, s17
    s_waitcnt vmcnt(10) lgkmcnt(0)
    v_perm_b32 v16, v68, v64, s16
    v_perm_b32 v17, v68, v64, s17
    v_perm_b32 v18, v69, v65, s16
    v_perm_b32 v19, v69, v65, s17
    v_perm_b32 v20, v70, v66, s16
    v_perm_b32 v21, v70, v66, s17
    v_perm_b32 v22, v71, v67, s16
    v_perm_b32 v23, v71, v67, s17
    v_dot2_f32_bf16 v8, v16, v28, v8
    v_dot2_f32_bf16 v9, v17, v28, v9
    v_dot2_f32_bf16 v10, v18, v28, v10
    v_dot2_f32_bf16 v11, v19, v28, v11
    v_dot2_f32_bf16 v12, v20, v28, v12
    v_dot2_f32_bf16 v13, v21, v28, v13
    v_dot2_f32_bf16 v14, v22, v28, v14
    v_dot2_f32_bf16 v15, v23, v28, v15
    s_waitcnt vmcnt(7)
    v_perm_b32 v16, v76, v72, s16
    v_perm_b32 v17, v76, v72, s17
    v_perm_b32 v18, v77, v73, s16
    v_perm_b32 v19, v77, v73, s17
    v_perm_b32 v20, v78, v74, s16
    v_perm_b32 v21, v78, v74, s17
    v_perm_b32 v22, v79, v75, s16
    v_perm_b32 v23, v79, v75, s17
    v_dot2_f32_bf16 v8, v16, v29, v8
    v_dot2_f32_bf16 v9, v17, v29, v9
    v_dot2_f32_bf16 v10, v18, v29, v10
    v_dot2_f32_bf16 v11, v19, v29, v11
    v_dot2_f32_bf16 v12, v20, v29, v12
    v_dot2_f32_bf16 v13, v21, v29, v13
    v_dot2_f32_bf16 v14, v22, v29, v14
    v_dot2_f32_bf16 v15, v23, v29, v15
    s_waitcnt vmcnt(4)
    v_perm_b32 v16, v84, v80, s16
    v_perm_b32 v17, v84, v80, s17
    v_perm_b32 v18, v85, v81, s16
    v_perm_b32 v19, v85, v81, s17
    v_perm_b32 v20, v86, v82, s16
    v_perm_b32 v21, v86, v82, s17
    v_perm_b32 v22, v87, v83, s16
    v_perm_b32 v23, v87, v83, s17
    v_dot2_f32_bf16 v8, v16, v30, v8
    v_dot2_f32_bf16 v9, v17, v30, v9
    v_dot2_f32_bf16 v10, v18, v30, v10
    v_dot2_f32_bf16 v11, v19, v30, v11
    v_dot2_f32_bf16 v12, v20, v30, v12
    v_dot2_f32_bf16 v13, v21, v30, v13
    v_dot2_f32_bf16 v14, v22, v30, v14
    v_dot2_f32_bf16 v15, v23, v30, v15
    v_perm_b32 v235, v244, v240, s16
    v_perm_b32 v244, v244, v240, s17
    v_perm_b32 v240, v245, v241, s16
    v_perm_b32 v245, v245, v241, s17
    v_perm_b32 v241, v246, v242, s16
    v_perm_b32 v246, v246, v242, s17
    v_perm_b32 v242, v247, v243, s16
    v_perm_b32 v247, v247, v243, s17
    s_waitcnt vmcnt(2)
    v_perm_b32 v16, v92, v88, s16
    v_perm_b32 v17, v92, v88, s17
    v_perm_b32 v18, v93, v89, s16
    v_perm_b32 v19, v93, v89, s17
    v_perm_b32 v20, v94, v90, s16
    v_perm_b32 v21, v94, v90, s17
    v_perm_b32 v22, v95, v91, s16
    v_perm_b32 v23, v95, v91, s17
    v_dot2_f32_bf16 v8, v16, v31, v8
    v_dot2_f32_bf16 v9, v17, v31, v9
    v_dot2_f32_bf16 v10, v18, v31, v10
    v_dot2_f32_bf16 v11, v19, v31, v11
    v_dot2_f32_bf16 v12, v20, v31, v12
    v_dot2_f32_bf16 v13, v21, v31, v13
    v_dot2_f32_bf16 v14, v22, v31, v14
    v_dot2_f32_bf16 v15, v23, v31, v15
    s_waitcnt vmcnt(0)
    v_perm_b32 v243, v252, v248, s16
    v_perm_b32 v252, v252, v248, s17
    v_perm_b32 v248, v253, v249, s16
    v_perm_b32 v253, v253, v249, s17
    v_perm_b32 v249, v254, v250, s16
    v_perm_b32 v254, v254, v250, s17
    v_perm_b32 v250, v255, v251, s16
    v_perm_b32 v255, v255, v251, s17
    v_permlane32_swap_b32 v8, v12
    v_permlane32_swap_b32 v9, v13
    v_permlane32_swap_b32 v10, v14
    v_permlane32_swap_b32 v11, v15
    v_add_f32 v8, v8, v12
    v_add_f32 v9, v9, v13
    v_add_f32 v10, v10, v14
    v_add_f32 v11, v11, v15
    ds_write_b128 v55, v[8:11] offset:8192
    s_waitcnt lgkmcnt(0)
    s_barrier
    s_cmp_ge_u32 s7, 2
    s_cbranch_scc1 L_sp3618
    v_lshlrev_b32 v16, 3, v0
    ds_read_b64 v[24:25], v16 offset:8192
    ds_read_b64 v[26:27], v16 offset:9216
    ds_read_b64 v[28:29], v16 offset:10240
    ds_read_b64 v[30:31], v16 offset:11264
    ds_read_b64 v[32:33], v16 offset:12288
    ds_read_b64 v[34:35], v16 offset:13312
    ds_read_b64 v[36:37], v16 offset:14336
    ds_read_b64 v[38:39], v16 offset:15360
    s_waitcnt lgkmcnt(0)
    v_add_f32 v24, v24, v26
    v_add_f32 v25, v25, v27
    v_add_f32 v24, v24, v28
    v_add_f32 v25, v25, v29
    v_add_f32 v24, v24, v30
    v_add_f32 v25, v25, v31
    v_add_f32 v24, v24, v32
    v_add_f32 v25, v25, v33
    v_add_f32 v24, v24, v34
    v_add_f32 v25, v25, v35
    v_add_f32 v24, v24, v36
    v_add_f32 v25, v25, v37
    v_add_f32 v24, v24, v38
    v_add_f32 v25, v25, v39
    v_cvt_pk_bf16_f32 v24, v24, v25
    v_lshlrev_b32 v16, 2, v0
    ds_write_b32 v16, v24 offset:16384
    s_waitcnt lgkmcnt(0)
    s_nop 1
L_sp3618:
    s_barrier
    s_cmp_eq_u32 s7, 7
    s_cbranch_scc1 L_w7
    v_lshlrev_b32 v16, 6, v52
    ds_read_b128 v[24:27], v16 offset:16384
    ds_read_b128 v[28:31], v16 offset:16400
    ds_read_b128 v[32:35], v16 offset:16416
    ds_read_b128 v[36:39], v16 offset:16432
    s_waitcnt lgkmcnt(3)
    v_dot2_f32_bf16 v8, v63, v24, 0
    v_dot2_f32_bf16 v9, v132, v24, 0
    v_dot2_f32_bf16 v10, v128, v24, 0
    v_dot2_f32_bf16 v11, v133, v24, 0
    v_dot2_f32_bf16 v12, v129, v24, 0
    v_dot2_f32_bf16 v13, v134, v24, 0
    v_dot2_f32_bf16 v14, v130, v24, 0
    v_dot2_f32_bf16 v15, v135, v24, 0
    v_dot2_f32_bf16 v8, v131, v25, v8
    v_dot2_f32_bf16 v9, v140, v25, v9
    v_dot2_f32_bf16 v10, v136, v25, v10
    v_dot2_f32_bf16 v11, v141, v25, v11
    v_dot2_f32_bf16 v12, v137, v25, v12
    v_dot2_f32_bf16 v13, v142, v25, v13
    v_dot2_f32_bf16 v14, v138, v25, v14
    v_dot2_f32_bf16 v15, v143, v25, v15
    v_dot2_f32_bf16 v8, v139, v26, v8
    v_dot2_f32_bf16 v9, v148, v26, v9
    v_dot2_f32_bf16 v10, v144, v26, v10
    v_dot2_f32_bf16 v11, v149, v26, v11
    v_dot2_f32_bf16 v12, v145, v26, v12
    v_dot2_f32_bf16 v13, v150, v26, v13
    v_dot2_f32_bf16 v14, v146, v26, v14
    v_dot2_f32_bf16 v15, v151, v26, v15
    v_dot2_f32_bf16 v8, v147, v27, v8
    v_dot2_f32_bf16 v9, v156, v27, v9
    v_dot2_f32_bf16 v10, v152, v27, v10
    v_dot2_f32_bf16 v11, v157, v27, v11
    v_dot2_f32_bf16 v12, v153, v27, v12
    v_dot2_f32_bf16 v13, v158, v27, v13
    v_dot2_f32_bf16 v14, v154, v27, v14
    v_dot2_f32_bf16 v15, v159, v27, v15
    s_waitcnt lgkmcnt(2)
    v_dot2_f32_bf16 v8, v155, v28, v8
    v_dot2_f32_bf16 v9, v164, v28, v9
    v_dot2_f32_bf16 v10, v160, v28, v10
    v_dot2_f32_bf16 v11, v165, v28, v11
    v_dot2_f32_bf16 v12, v161, v28, v12
    v_dot2_f32_bf16 v13, v166, v28, v13
    v_dot2_f32_bf16 v14, v162, v28, v14
    v_dot2_f32_bf16 v15, v167, v28, v15
    v_dot2_f32_bf16 v8, v163, v29, v8
    v_dot2_f32_bf16 v9, v172, v29, v9
    v_dot2_f32_bf16 v10, v168, v29, v10
    v_dot2_f32_bf16 v11, v173, v29, v11
    v_dot2_f32_bf16 v12, v169, v29, v12
    v_dot2_f32_bf16 v13, v174, v29, v13
    v_dot2_f32_bf16 v14, v170, v29, v14
    v_dot2_f32_bf16 v15, v175, v29, v15
    v_dot2_f32_bf16 v8, v171, v30, v8
    v_dot2_f32_bf16 v9, v180, v30, v9
    v_dot2_f32_bf16 v10, v176, v30, v10
    v_dot2_f32_bf16 v11, v181, v30, v11
    v_dot2_f32_bf16 v12, v177, v30, v12
    v_dot2_f32_bf16 v13, v182, v30, v13
    v_dot2_f32_bf16 v14, v178, v30, v14
    v_dot2_f32_bf16 v15, v183, v30, v15
    v_dot2_f32_bf16 v8, v179, v31, v8
    v_dot2_f32_bf16 v9, v188, v31, v9
    v_dot2_f32_bf16 v10, v184, v31, v10
    v_dot2_f32_bf16 v11, v189, v31, v11
    v_dot2_f32_bf16 v12, v185, v31, v12
    v_dot2_f32_bf16 v13, v190, v31, v13
    v_dot2_f32_bf16 v14, v186, v31, v14
    v_dot2_f32_bf16 v15, v191, v31, v15
    s_waitcnt lgkmcnt(1)
    v_dot2_f32_bf16 v8, v187, v32, v8
    v_dot2_f32_bf16 v9, v196, v32, v9
    v_dot2_f32_bf16 v10, v192, v32, v10
    v_dot2_f32_bf16 v11, v197, v32, v11
    v_dot2_f32_bf16 v12, v193, v32, v12
    v_dot2_f32_bf16 v13, v198, v32, v13
    v_dot2_f32_bf16 v14, v194, v32, v14
    v_dot2_f32_bf16 v15, v199, v32, v15
    v_dot2_f32_bf16 v8, v195, v33, v8
    v_dot2_f32_bf16 v9, v204, v33, v9
    v_dot2_f32_bf16 v10, v200, v33, v10
    v_dot2_f32_bf16 v11, v205, v33, v11
    v_dot2_f32_bf16 v12, v201, v33, v12
    v_dot2_f32_bf16 v13, v206, v33, v13
    v_dot2_f32_bf16 v14, v202, v33, v14
    v_dot2_f32_bf16 v15, v207, v33, v15
    v_dot2_f32_bf16 v8, v203, v34, v8
    v_dot2_f32_bf16 v9, v212, v34, v9
    v_dot2_f32_bf16 v10, v208, v34, v10
    v_dot2_f32_bf16 v11, v213, v34, v11
    v_dot2_f32_bf16 v12, v209, v34, v12
    v_dot2_f32_bf16 v13, v214, v34, v13
    v_dot2_f32_bf16 v14, v210, v34, v14
    v_dot2_f32_bf16 v15, v215, v34, v15
    v_dot2_f32_bf16 v8, v211, v35, v8
    v_dot2_f32_bf16 v9, v220, v35, v9
    v_dot2_f32_bf16 v10, v216, v35, v10
    v_dot2_f32_bf16 v11, v221, v35, v11
    v_dot2_f32_bf16 v12, v217, v35, v12
    v_dot2_f32_bf16 v13, v222, v35, v13
    v_dot2_f32_bf16 v14, v218, v35, v14
    v_dot2_f32_bf16 v15, v223, v35, v15
    s_waitcnt lgkmcnt(0)
    v_dot2_f32_bf16 v8, v219, v36, v8
    v_dot2_f32_bf16 v9, v228, v36, v9
    v_dot2_f32_bf16 v10, v224, v36, v10
    v_dot2_f32_bf16 v11, v229, v36, v11
    v_dot2_f32_bf16 v12, v225, v36, v12
    v_dot2_f32_bf16 v13, v230, v36, v13
    v_dot2_f32_bf16 v14, v226, v36, v14
    v_dot2_f32_bf16 v15, v231, v36, v15
    v_dot2_f32_bf16 v8, v227, v37, v8
    v_dot2_f32_bf16 v9, v236, v37, v9
    v_dot2_f32_bf16 v10, v232, v37, v10
    v_dot2_f32_bf16 v11, v237, v37, v11
    v_dot2_f32_bf16 v12, v233, v37, v12
    v_dot2_f32_bf16 v13, v238, v37, v13
    v_dot2_f32_bf16 v14, v234, v37, v14
    v_dot2_f32_bf16 v15, v239, v37, v15
    v_dot2_f32_bf16 v8, v235, v38, v8
    v_dot2_f32_bf16 v9, v244, v38, v9
    v_dot2_f32_bf16 v10, v240, v38, v10
    v_dot2_f32_bf16 v11, v245, v38, v11
    v_dot2_f32_bf16 v12, v241, v38, v12
    v_dot2_f32_bf16 v13, v246, v38, v13
    v_dot2_f32_bf16 v14, v242, v38, v14
    v_dot2_f32_bf16 v15, v247, v38, v15
    v_dot2_f32_bf16 v8, v243, v39, v8
    v_dot2_f32_bf16 v9, v252, v39, v9
    v_dot2_f32_bf16 v10, v248, v39, v10
    v_dot2_f32_bf16 v11, v253, v39, v11
    v_dot2_f32_bf16 v12, v249, v39, v12
    v_dot2_f32_bf16 v13, v254, v39, v13
    v_dot2_f32_bf16 v14, v250, v39, v14
    v_dot2_f32_bf16 v15, v255, v39, v15
    v_permlane32_swap_b32 v8, v12
    v_permlane32_swap_b32 v9, v13
    v_permlane32_swap_b32 v10, v14
    v_permlane32_swap_b32 v11, v15
    v_add_f32 v8, v8, v12
    v_add_f32 v9, v9, v13
    v_add_f32 v10, v10, v14
    v_add_f32 v11, v11, v15
    s_nop 0
    v_permlane16_swap_b32 v8, v10
    v_permlane16_swap_b32 v9, v11
    v_add_f32 v8, v8, v10
    v_add_f32 v9, v9, v11
    s_nop 0
    v_add_f32_dpp v10, v8, v8 row_ror:8 row_mask:0xf bank_mask:0x3
    v_add_f32_dpp v10, v9, v9 row_ror:8 row_mask:0xf bank_mask:0xc
    s_add_u32 s14, s6, 0
    buffer_store_dword v10, v61, s[76:79], s14 offen sc1
    s_nop 1
    s_branch L_pub
L_w7:
    v_mov_b32 v16, 0
    ds_read_b128 v[8:11], v16 offset:29728
    ds_read_b128 v[12:15], v16 offset:29744
    s_waitcnt lgkmcnt(0)
    v_add_f32 v8, v8, v9
    v_add_f32 v8, v8, v10
    v_add_f32 v8, v8, v11
    v_add_f32 v8, v8, v12
    v_add_f32 v8, v8, v13
    v_add_f32 v8, v8, v14
    v_add_f32 v8, v8, v15
    v_mov_b32 v59, v8
    s_lshl_b32 s14, s4, 5
    s_or_b32 s14, s14, s8
    s_lshl_b32 s14, s14, 3
    s_add_u32 s14, s14, 1048576
    s_mov_b64 exec, 1
    buffer_store_dwordx2 v[58:59], v16, s[76:79], s14 offen sc1
    s_mov_b64 exec, -1
L_pub:
    s_waitcnt vmcnt(0)
    s_barrier
    s_cmp_lg_u32 s7, 0
    s_cbranch_scc1 L_noat
    v_mov_b32 v20, 1
    s_lshl_b32 s14, s4, 4
    v_mov_b32 v21, s14
    s_mov_b64 exec, 1
    buffer_atomic_add v20, v21, s[80:83], 0 offen offset:128 sc0
    s_waitcnt vmcnt(0)
    v_mov_b32 v21, 0
    ds_write_b32 v21, v20 offset:29764
    s_mov_b64 exec, -1
    s_waitcnt lgkmcnt(0)
    s_nop 0
L_noat:
    s_barrier
    v_mov_b32 v21, 0
    ds_read_b32 v20, v21 offset:29764
    s_waitcnt lgkmcnt(0)
    v_readfirstlane_b32 s14, v20
    s_nop 1
    s_cmp_lg_u32 s14, 31
    s_cbranch_scc1 L_fin
    s_cmp_eq_u32 s7, 7
    s_cbranch_scc1 L_fin
    s_mul_i32 s14, s4, 57344
    s_lshl_b32 s15, s4, 8
    s_add_u32 s15, s15, 1048576
    buffer_load_dwordx2 v[20:21], v44, s[76:79], s15 offen sc1
    buffer_load_dwordx4 v[64:67], v42, s[76:79], s14 offen offset:0 sc1
    buffer_load_dwordx4 v[68:71], v42, s[76:79], s14 offen offset:1792 sc1
    s_add_u32 s14, s14, s20
    buffer_load_dwordx4 v[72:75], v42, s[76:79], s14 offen offset:0 sc1
    buffer_load_dwordx4 v[76:79], v42, s[76:79], s14 offen offset:1792 sc1
    s_add_u32 s14, s14, s20
    buffer_load_dwordx4 v[80:83], v42, s[76:79], s14 offen offset:0 sc1
    buffer_load_dwordx4 v[84:87], v42, s[76:79], s14 offen offset:1792 sc1
    s_add_u32 s14, s14, s20
    buffer_load_dwordx4 v[88:91], v42, s[76:79], s14 offen offset:0 sc1
    buffer_load_dwordx4 v[92:95], v42, s[76:79], s14 offen offset:1792 sc1
    s_add_u32 s14, s14, s20
    s_add_u32 s14, s14, 509952
    buffer_load_dwordx4 v[96:99], v42, s[76:79], s14 offen offset:0 sc1
    buffer_load_dwordx4 v[100:103], v42, s[76:79], s14 offen offset:1792 sc1
    s_add_u32 s14, s14, s20
    buffer_load_dwordx4 v[104:107], v42, s[76:79], s14 offen offset:0 sc1
    buffer_load_dwordx4 v[108:111], v42, s[76:79], s14 offen offset:1792 sc1
    s_add_u32 s14, s14, s20
    buffer_load_dwordx4 v[112:115], v42, s[76:79], s14 offen offset:0 sc1
    buffer_load_dwordx4 v[116:119], v42, s[76:79], s14 offen offset:1792 sc1
    s_add_u32 s14, s14, s20
    buffer_load_dwordx4 v[120:123], v42, s[76:79], s14 offen offset:0 sc1
    buffer_load_dwordx4 v[124:127], v42, s[76:79], s14 offen offset:1792 sc1
    s_waitcnt vmcnt(16)
    v_mov_b32_dpp v22, v20 quad_perm:[1,0,3,2] row_mask:0xf bank_mask:0xf
    v_mov_b32_dpp v23, v21 quad_perm:[1,0,3,2] row_mask:0xf bank_mask:0xf
    v_max_f32 v24, v20, v22
    v_sub_f32 v25, v20, v24
    v_sub_f32 v27, v22, v24
    v_mul_f32 v25, s18, v25
    v_mul_f32 v27, s18, v27
    v_exp_f32 v25, v25
    v_exp_f32 v27, v27
    v_mul_f32 v28, v25, v21
    v_fmac_f32 v28, v27, v23
    v_rcp_f32 v27, v28
    s_nop 0
    v_fma_f32 v29, -v28, v27, 1.0
    v_fma_f32 v27, v29, v27, v27
    v_mul_f32 v25, v25, v27
    ds_bpermute_b32 v28, v43, v25 offset:0
    ds_bpermute_b32 v29, v43, v25 offset:4
    ds_bpermute_b32 v30, v43, v25 offset:8
    ds_bpermute_b32 v31, v43, v25 offset:12
    ds_bpermute_b32 v32, v43, v25 offset:16
    ds_bpermute_b32 v33, v43, v25 offset:20
    ds_bpermute_b32 v34, v43, v25 offset:24
    ds_bpermute_b32 v35, v43, v25 offset:28
    s_waitcnt vmcnt(15) lgkmcnt(7)
    v_mul_f32 v8, v28, v64
    v_mul_f32 v9, v28, v65
    v_mul_f32 v10, v28, v66
    v_mul_f32 v11, v28, v67
    s_waitcnt vmcnt(14) lgkmcnt(6)
    v_fmac_f32 v8, v29, v68
    v_fmac_f32 v9, v29, v69
    v_fmac_f32 v10, v29, v70
    v_fmac_f32 v11, v29, v71
    s_waitcnt vmcnt(13) lgkmcnt(5)
    v_fmac_f32 v8, v30, v72
    v_fmac_f32 v9, v30, v73
    v_fmac_f32 v10, v30, v74
    v_fmac_f32 v11, v30, v75
    s_waitcnt vmcnt(12) lgkmcnt(4)
    v_fmac_f32 v8, v31, v76
    v_fmac_f32 v9, v31, v77
    v_fmac_f32 v10, v31, v78
    v_fmac_f32 v11, v31, v79
    s_waitcnt vmcnt(11) lgkmcnt(3)
    v_fmac_f32 v8, v32, v80
    v_fmac_f32 v9, v32, v81
    v_fmac_f32 v10, v32, v82
    v_fmac_f32 v11, v32, v83
    s_waitcnt vmcnt(10) lgkmcnt(2)
    v_fmac_f32 v8, v33, v84
    v_fmac_f32 v9, v33, v85
    v_fmac_f32 v10, v33, v86
    v_fmac_f32 v11, v33, v87
    s_waitcnt vmcnt(9) lgkmcnt(1)
    v_fmac_f32 v8, v34, v88
    v_fmac_f32 v9, v34, v89
    v_fmac_f32 v10, v34, v90
    v_fmac_f32 v11, v34, v91
    s_waitcnt vmcnt(8) lgkmcnt(0)
    v_fmac_f32 v8, v35, v92
    v_fmac_f32 v9, v35, v93
    v_fmac_f32 v10, v35, v94
    v_fmac_f32 v11, v35, v95
    s_nop 0
    v_permlane32_swap_b32 v8, v10
    v_permlane32_swap_b32 v9, v11
    v_add_f32 v8, v8, v10
    v_add_f32 v9, v9, v11
    s_nop 1
    v_permlane16_swap_b32 v8, v9
    v_add_f32 v8, v8, v9
    v_lshlrev_b32 v41, 16, v41
    v_cvt_pk_bf16_f32 v8, v8, v8
    v_lshlrev_b32 v8, 16, v8
    v_add_f32 v8, v41, v8
    v_cvt_pk_bf16_f32 v8, v8, v8
    v_lshlrev_b32 v8, 16, v8
    s_waitcnt vmcnt(6)
    v_add_f32 v12, v96, v100
    v_add_f32 v13, v97, v101
    v_add_f32 v14, v98, v102
    v_add_f32 v15, v99, v103
    s_waitcnt vmcnt(5)
    v_add_f32 v12, v12, v104
    v_add_f32 v13, v13, v105
    v_add_f32 v14, v14, v106
    v_add_f32 v15, v15, v107
    s_waitcnt vmcnt(4)
    v_add_f32 v12, v12, v108
    v_add_f32 v13, v13, v109
    v_add_f32 v14, v14, v110
    v_add_f32 v15, v15, v111
    s_waitcnt vmcnt(3)
    v_add_f32 v12, v12, v112
    v_add_f32 v13, v13, v113
    v_add_f32 v14, v14, v114
    v_add_f32 v15, v15, v115
    s_waitcnt vmcnt(2)
    v_add_f32 v12, v12, v116
    v_add_f32 v13, v13, v117
    v_add_f32 v14, v14, v118
    v_add_f32 v15, v15, v119
    s_waitcnt vmcnt(1)
    v_add_f32 v12, v12, v120
    v_add_f32 v13, v13, v121
    v_add_f32 v14, v14, v122
    v_add_f32 v15, v15, v123
    s_waitcnt vmcnt(0)
    v_add_f32 v12, v12, v124
    v_add_f32 v13, v13, v125
    v_add_f32 v14, v14, v126
    v_add_f32 v15, v15, v127
    s_nop 0
    v_permlane32_swap_b32 v12, v14
    v_permlane32_swap_b32 v13, v15
    v_add_f32 v12, v12, v14
    v_add_f32 v13, v13, v15
    s_nop 1
    v_permlane16_swap_b32 v12, v13
    v_add_f32 v47, v12, v13
    v_cvt_pk_bf16_f32 v9, v47, v47
    v_lshlrev_b32 v9, 16, v9
    v_add_f32 v8, v8, v9
    v_cvt_pk_bf16_f32 v8, v8, v8
    s_mul_i32 s14, s4, 896
    buffer_store_short v8, v40, s[84:87], s14 offen
    s_nop 1
L_fin:
L_end:
    s_endpgm
L_code_end:
.section .rodata,"a"
.p2align 6
.amdhsa_kernel parallel_sum__mha_block_cached__glu_gated_glu__decode_kernel
  .amdhsa_next_free_vgpr 256
  .amdhsa_next_free_sgpr 102
  .amdhsa_accum_offset 256
  .amdhsa_group_segment_fixed_size 0
  .amdhsa_kernarg_size 96
  .amdhsa_user_sgpr_count 2
  .amdhsa_user_sgpr_kernarg_segment_ptr 1
  .amdhsa_system_sgpr_workgroup_id_x 1
.end_amdhsa_kernel
```
